```python
import torch

def _softmax(x, axis=-1):
    return torch.softmax(x, dim=axis)
def _gelu(x):
    return torch.nn.functional.gelu(x, approximate="tanh")
def _silu(x):
    return torch.nn.functional.silu(x)
def _sigmoid(x):
    return torch.sigmoid(x)
def _layernorm(x, axis=-1, eps=1e-5):
    m = x.mean(dim=axis, keepdim=True)
    v = x.var(dim=axis, keepdim=True, unbiased=False)
    return (x - m) / torch.sqrt(v + eps)
def _scatter_add(tgt, idx, src, axis=0):
    return tgt.clone().index_add_(axis, idx, src)
def _segment_sum(src, seg, n):
    out = torch.zeros((n,) + src.shape[1:], dtype=src.dtype)
    return out.index_add_(0, seg, src)
def _pad(x, pw):
    flat = tuple(v for pair in reversed(pw) for v in pair)
    return torch.nn.functional.pad(x, flat)

kernel_name = 'gated_mix__mha_block__geglu_ffn__prompt'

def setup_inputs():

    _w = (lambda a: (lambda t: t.to(torch.bfloat16) if t.is_floating_point() else t)(torch.as_tensor(a)))
    def _A_setup():
        B, S, D, H = 1, 2048, 512, 32
        return {
            "x": _w((lambda *s: torch.randn(*s, dtype=torch.bfloat16) * 0.05)(B, S, D)),
            "wqkv": _w((lambda *s: torch.randn(*s, dtype=torch.bfloat16) * 0.8)(D, 3 * D)),
            "wo": _w((lambda *s: torch.randn(*s, dtype=torch.bfloat16) * 0.05)(D, D)),
        }
    _A_in = _A_setup()

    def _B_setup():
        B, S, D, F = 1, 2048, 512, 1376
        return {
            "x": _w((lambda *s: torch.randn(*s, dtype=torch.bfloat16) * 0.05)(B, S, D)),
            "w_gate": _w((lambda *s: torch.randn(*s, dtype=torch.bfloat16) * 0.1)(D, F)),
            "w_up": _w((lambda *s: torch.randn(*s, dtype=torch.bfloat16) * 0.1)(D, F)),
            "w_down": _w((lambda *s: torch.randn(*s, dtype=torch.bfloat16) * 0.1)(F, D)),
        }
    _B_in = _B_setup()

    return {
        "A_x": _A_in["x"],
        "A_wqkv": _A_in["wqkv"],
        "A_wo": _A_in["wo"],
        "B_x": _B_in["x"],
        "B_w_gate": _B_in["w_gate"],
        "B_w_up": _B_in["w_up"],
        "B_w_down": _B_in["w_down"],
        "gate_w": _w((lambda *s: torch.randn(*s, dtype=torch.bfloat16) * 0.05)(512) * 16.0),
    }

def reference(A_x, A_wqkv, A_wo, B_x, B_w_gate, B_w_up, B_w_down, gate_w):
    def _A_ref(x, wqkv, wo):
        B, S, D = x.shape
        H = 32
        Dh = D // H
        qkv = (lambda x, *d: x.permute(*d))((x @ wqkv).reshape(B, S, 3, H, Dh), 2, 0, 3, 1, 4)
        q, k, v = qkv[0], qkv[1], qkv[2]
        scores = torch.einsum("bhqd,bhkd->bhqk", q, k) * (Dh ** -0.5)
        p = _softmax(scores, axis=-1)
        o = torch.einsum("bhqk,bhkd->bhqd", p, v)
        return (lambda x, *d: x.permute(*d))(o, 0, 2, 1, 3).reshape(B, S, D) @ wo

    def _B_ref(x, w_gate, w_up, w_down):
        return (_gelu(x @ w_gate) * (x @ w_up)) @ w_down

    x = A_x
    g = _sigmoid((x * gate_w).sum(-1, keepdims=True))
    a = _A_ref(x, A_wqkv, A_wo)
    b = _B_ref(x, B_w_gate, B_w_up, B_w_down)
    return g * a + (1 - g) * b
```

```asm
; @launch grid=(256,1,1) block=(512,1,1) lds=163840
.amdgcn_target "amdgcn-amd-amdhsa--gfx950"
.text
.globl gated_mix__mha_block__geglu_ffn__prompt_kernel
.p2align 8
.type gated_mix__mha_block__geglu_ffn__prompt_kernel,@function
gated_mix__mha_block__geglu_ffn__prompt_kernel:
    s_cmp_ge_u32 s2, 256
    s_cbranch_scc1 exit_1
    s_load_dwordx4 s[4:7], s[0:1], 0
    s_load_dwordx4 s[8:11], s[0:1], 32
    s_load_dwordx2 s[28:29], s[0:1], 56
    s_load_dwordx2 s[60:61], s[0:1], 80
    s_load_dwordx2 s[40:41], s[0:1], 48
    s_load_dwordx2 s[44:45], s[0:1], 16
    s_load_dwordx2 s[48:49], s[0:1], 64
    v_readfirstlane_b32 s3, v0
    v_and_b32 v1, 63, v0
    s_lshr_b32 s3, s3, 6
    s_getpc_b64 s[30:31]
cpf_here_3:
    s_and_b32 s33, s2, 0xf8
    s_add_u32 s33, s33, s3
    s_mul_i32 s33, s33, 2
    v_add_u32 v212, s33, v1
    v_lshlrev_b32 v212, 7, v212
    v_min_u32 v212, cpf_end-cpf_here_3-4, v212
    v_add_co_u32 v212, vcc, s30, v212
    v_mov_b32 v213, s31
    s_mov_b64 exec, 3
    v_addc_co_u32 v213, vcc, 0, v213, vcc
    global_load_dword v214, v[212:213], off
    s_mov_b64 exec, -1
    s_and_b32 s30, s2, 7
    s_lshr_b32 s31, s2, 3
    s_and_b32 s12, s30, 1
    s_lshl_b32 s12, s12, 3
    s_and_b32 s33, s31, 7
    s_add_u32 s12, s12, s33
    s_lshr_b32 s13, s30, 1
    s_lshl_b32 s13, s13, 2
    s_lshr_b32 s34, s31, 3
    s_add_u32 s13, s13, s34
    s_mul_i32 s34, s34, 2
    s_add_u32 s14, s33, s34
    s_and_b32 s15, s3, 3
    s_cmp_ge_u32 s3, 4
    s_cbranch_scc0 p12_h0_5
    v_lshrrev_b32 v2, 3, v1
    v_lshrrev_b32 v3, 4, v1
    v_and_b32 v4, 7, v1
    v_xor_b32 v3, v3, v4
    v_lshlrev_b32 v3, 4, v3
    v_lshl_add_u32 v154, v2, 10, v3
    v_xor_b32 v155, 64, v154
    s_lshl_b32 s64, s12, 17
    s_lshl_b32 s65, s15, 15
    s_add_u32 s64, s64, s65
    s_lshl_b32 s66, s15, 12
    s_lshl_b32 s65, s14, 7
    v_lshl_add_u32 v2, v1, 4, s65
    v_and_b32 v2, 1023, v2
    s_waitcnt lgkmcnt(0)
    s_mov_b32 s16, s4
    s_mov_b32 s17, s5
    s_mov_b32 s18, 2097152
    s_mov_b32 s19, 0x20000
    s_add_u32 s67, s14, 0
    s_and_b32 s67, s67, 7
    s_lshl_b32 s67, s67, 7
    s_add_u32 s67, s67, s64
    s_add_u32 m0, s66, 0
    s_nop 0
    buffer_load_dwordx4 v154, s[16:19], s67 offen lds
    s_add_u32 m0, s66, 1024
    s_add_u32 s67, s67, 8192
    buffer_load_dwordx4 v155, s[16:19], s67 offen lds
    s_add_u32 m0, s66, 2048
    s_add_u32 s67, s67, 8192
    buffer_load_dwordx4 v154, s[16:19], s67 offen lds
    s_add_u32 m0, s66, 3072
    s_add_u32 s67, s67, 8192
    buffer_load_dwordx4 v155, s[16:19], s67 offen lds
    s_mov_b32 s36, s28
    s_mov_b32 s37, s29
    s_mov_b32 s38, 1024
    s_mov_b32 s39, 0x20000
    s_mov_b32 m0, 143360
    s_nop 0
    buffer_load_dwordx4 v2, s[36:39], 0 offen lds
    s_branch p12_h1_4
p12_h0_5:
    s_mov_b32 s62, 43691
    v_add_u32 v2, 0, v1
    v_mul_lo_u32 v3, v2, s62
    v_lshrrev_b32 v240, 19, v3
    v_mul_u32_u24 v3, 12, v240
    v_sub_u32 v243, v2, v3
    v_add_u32 v2, 64, v1
    v_mul_lo_u32 v3, v2, s62
    v_lshrrev_b32 v241, 19, v3
    v_mul_u32_u24 v3, 12, v241
    v_sub_u32 v244, v2, v3
    v_add_u32 v2, 128, v1
    v_mul_lo_u32 v3, v2, s62
    v_lshrrev_b32 v242, 19, v3
    v_mul_u32_u24 v3, 12, v242
    v_sub_u32 v245, v2, v3
    s_mul_i32 s63, s15, 3072
    s_lshl_b32 s64, s13, 7
    s_lshl_b32 s65, s13, 6
    s_add_u32 s65, s65, 1920
    v_mov_b32 v4, s64
    v_mov_b32 v5, s65
    v_cmp_le_u32 vcc, 8, v243
    v_mul_u32_u24 v2, 3072, v240
    v_lshl_add_u32 v2, v243, 4, v2
    v_cndmask_b32 v3, v4, v5, vcc
    v_add_u32 v154, v2, v3
    v_cmp_le_u32 vcc, 8, v244
    v_mul_u32_u24 v2, 3072, v241
    v_lshl_add_u32 v2, v244, 4, v2
    v_cndmask_b32 v3, v4, v5, vcc
    v_add_u32 v155, v2, v3
    v_cmp_le_u32 vcc, 8, v245
    v_mul_u32_u24 v2, 3072, v242
    v_lshl_add_u32 v2, v245, 4, v2
    v_cndmask_b32 v3, v4, v5, vcc
    v_add_u32 v156, v2, v3
    s_mul_i32 s64, s15, 49152
    s_add_u32 s66, s63, 16384
    s_waitcnt lgkmcnt(0)
    s_mov_b32 s16, s6
    s_mov_b32 s17, s7
    s_mov_b32 s18, 1572864
    s_mov_b32 s19, 0x20000
    s_add_u32 s67, s14, 0
    s_and_b32 s67, s67, 7
    s_mul_i32 s67, s67, 196608
    s_add_u32 s67, s67, s64
    s_add_u32 m0, s66, 0
    s_nop 0
    buffer_load_dwordx4 v154, s[16:19], s67 offen lds
    s_add_u32 m0, s66, 1024
    s_nop 0
    buffer_load_dwordx4 v155, s[16:19], s67 offen lds
    s_add_u32 m0, s66, 2048
    s_nop 0
    buffer_load_dwordx4 v156, s[16:19], s67 offen lds
    s_mov_b32 s20, s8
    s_mov_b32 s21, s9
    s_mov_b32 s22, 1409024
    s_mov_b32 s23, 0x20000
    s_mov_b32 s24, s60
    s_mov_b32 s25, s61
    s_mov_b32 s26, 15728640
    s_mov_b32 s27, 0x20000
    v_and_b32 v5, 31, v1
    v_lshrrev_b32 v6, 5, v1
    v_lshrrev_b32 v7, 1, v5
    v_and_b32 v7, 7, v7
    v_xor_b32 v7, v7, v6
    v_lshlrev_b32 v7, 4, v7
    v_lshl_add_u32 v7, v5, 7, v7
    s_lshl_b32 s68, s15, 12
    v_add_u32 v136, s68, v7
    v_xor_b32 v137, 32, v136
    v_xor_b32 v138, 64, v136
    v_xor_b32 v139, 96, v136
    v_add_u32 v140, 57344, v136
    v_add_u32 v141, 57344, v137
    v_add_u32 v142, 57344, v138
    v_add_u32 v143, 57344, v139
    v_add_u32 v144, 114688, v136
    v_add_u32 v145, 114688, v137
    v_add_u32 v146, 114688, v138
    v_add_u32 v147, 114688, v139
    v_bfe_u32 v2, v1, 2, 2
    v_lshl_add_u32 v2, v6, 3, v2
    v_mul_u32_u24 v2, 192, v2
    v_and_b32 v3, 3, v1
    v_lshl_add_u32 v2, v3, 3, v2
    v_bfe_u32 v3, v1, 4, 1
    v_lshl_add_u32 v148, v3, 5, v2
    v_add_u32 v148, 16384, v148
    v_mul_u32_u24 v3, 12320, v3
    v_add_u32 v151, v2, v3
    v_add_u32 v149, 57344, v148
    v_add_u32 v152, 57344, v151
    v_add_u32 v150, 114688, v148
    v_add_u32 v153, 114688, v151
    v_mul_u32_u24 v2, 2752, v240
    v_lshl_add_u32 v157, v243, 4, v2
    v_mul_u32_u24 v2, 2752, v241
    v_lshl_add_u32 v158, v244, 4, v2
    v_mul_u32_u24 v2, 2752, v242
    v_lshl_add_u32 v159, v245, 4, v2
    s_mul_i32 s65, s15, 44032
    s_mul_i32 s68, s13, 192
    s_add_u32 s65, s65, s68
    v_lshlrev_b32 v2, 4, v1
    s_mov_b32 s100, 14778368
    s_buffer_load_dword s100, s[24:27], s100
    s_mov_b32 s42, 1409024
    s_mov_b32 s43, 0x20000
    s_mov_b32 s46, 524288
    s_mov_b32 s47, 0x20000
    s_mov_b32 s50, 2097152
    s_mov_b32 s51, 0x20000
    s_lshl_b32 s68, s3, 10
    s_add_u32 s68, s68, 155648
    v_add_u32 v160, s68, v2
    v_mov_b64 v[164:165], 0
    v_mov_b64 v[166:167], 0
    ds_write_b128 v160, v[164:167]
    s_lshl_b32 s68, s3, 2
    s_add_u32 s68, s68, 155616
    v_mov_b32 v161, s68
    v_mov_b32 v162, -1
    ds_write_b32 v161, v162
    s_add_u32 s67, s14, 1
    s_and_b32 s67, s67, 7
    s_mul_i32 s67, s67, 196608
    s_add_u32 s67, s67, s64
    s_add_u32 m0, s66, 28672
    s_nop 0
    buffer_load_dwordx4 v154, s[16:19], s67 offen lds
    s_add_u32 m0, s66, 29696
    s_nop 0
    buffer_load_dwordx4 v155, s[16:19], s67 offen lds
    s_add_u32 m0, s66, 30720
    s_nop 0
    buffer_load_dwordx4 v156, s[16:19], s67 offen lds
    s_add_u32 s67, s14, 2
    s_and_b32 s67, s67, 7
    s_mul_i32 s67, s67, 196608
    s_add_u32 s67, s67, s64
    s_add_u32 m0, s66, 57344
    s_nop 0
    buffer_load_dwordx4 v154, s[16:19], s67 offen lds
    s_add_u32 m0, s66, 58368
    s_nop 0
    buffer_load_dwordx4 v155, s[16:19], s67 offen lds
    s_add_u32 m0, s66, 59392
    s_nop 0
    buffer_load_dwordx4 v156, s[16:19], s67 offen lds
    s_waitcnt vmcnt(6)
    s_barrier
    ds_read_b128 v[8:11], v136 offset:0
    ds_read_b64_tr_b16 v[216:217], v148 offset:0
    ds_read_b64_tr_b16 v[218:219], v148 offset:768
    ds_read_b64_tr_b16 v[220:221], v148 offset:64
    ds_read_b64_tr_b16 v[222:223], v148 offset:832
    ds_read_b128 v[12:15], v137 offset:0
    ds_read_b64_tr_b16 v[228:229], v148 offset:3072
    ds_read_b64_tr_b16 v[230:231], v148 offset:3840
    ds_read_b64_tr_b16 v[232:233], v148 offset:3136
    ds_read_b64_tr_b16 v[234:235], v148 offset:3904
    s_waitcnt lgkmcnt(5)
    v_mfma_f32_32x32x16_bf16 v[168:183], v[216:219], v[8:11], 0
    v_mfma_f32_32x32x16_bf16 v[184:199], v[220:223], v[8:11], 0
    ds_read_b128 v[16:19], v138 offset:0
    ds_read_b64_tr_b16 v[216:217], v148 offset:6144
    ds_read_b64_tr_b16 v[218:219], v148 offset:6912
    ds_read_b64_tr_b16 v[220:221], v148 offset:6208
    ds_read_b64_tr_b16 v[222:223], v148 offset:6976
    s_waitcnt lgkmcnt(5)
    v_mfma_f32_32x32x16_bf16 v[168:183], v[228:231], v[12:15], v[168:183]
    v_mfma_f32_32x32x16_bf16 v[184:199], v[232:235], v[12:15], v[184:199]
    s_add_u32 s67, s14, 3
    s_and_b32 s67, s67, 7
    s_mul_i32 s67, s67, 196608
    s_add_u32 s67, s67, s64
    s_add_u32 m0, s66, 86016
    s_nop 0
    buffer_load_dwordx4 v154, s[16:19], s67 offen lds
    ds_read_b128 v[20:23], v139 offset:0
    ds_read_b64_tr_b16 v[228:229], v148 offset:9216
    ds_read_b64_tr_b16 v[230:231], v148 offset:9984
    ds_read_b64_tr_b16 v[232:233], v148 offset:9280
    ds_read_b64_tr_b16 v[234:235], v148 offset:10048
    s_waitcnt lgkmcnt(5)
    v_mfma_f32_32x32x16_bf16 v[168:183], v[216:219], v[16:19], v[168:183]
    v_mfma_f32_32x32x16_bf16 v[184:199], v[220:223], v[16:19], v[184:199]
    s_add_u32 m0, s66, 87040
    s_nop 0
    buffer_load_dwordx4 v155, s[16:19], s67 offen lds
    s_waitcnt vmcnt(5) lgkmcnt(0)
    s_barrier
    ds_read_b128 v[24:27], v136 offset:28672
    ds_read_b64_tr_b16 v[216:217], v148 offset:28672
    ds_read_b64_tr_b16 v[218:219], v148 offset:29440
    ds_read_b64_tr_b16 v[220:221], v148 offset:28736
    ds_read_b64_tr_b16 v[222:223], v148 offset:29504
    v_mfma_f32_32x32x16_bf16 v[168:183], v[228:231], v[20:23], v[168:183]
    v_mfma_f32_32x32x16_bf16 v[184:199], v[232:235], v[20:23], v[184:199]
    s_add_u32 m0, s66, 88064
    s_nop 0
    buffer_load_dwordx4 v156, s[16:19], s67 offen lds
    ds_read_b128 v[28:31], v137 offset:28672
    ds_read_b64_tr_b16 v[228:229], v148 offset:31744
    ds_read_b64_tr_b16 v[230:231], v148 offset:32512
    ds_read_b64_tr_b16 v[232:233], v148 offset:31808
    ds_read_b64_tr_b16 v[234:235], v148 offset:32576
    s_waitcnt lgkmcnt(5)
    v_mfma_f32_32x32x16_bf16 v[168:183], v[216:219], v[24:27], v[168:183]
    v_mfma_f32_32x32x16_bf16 v[184:199], v[220:223], v[24:27], v[184:199]
    s_add_u32 s100, s100, 0x9E3779B9
    ds_read_b128 v[32:35], v138 offset:28672
    ds_read_b64_tr_b16 v[216:217], v148 offset:34816
    ds_read_b64_tr_b16 v[218:219], v148 offset:35584
    ds_read_b64_tr_b16 v[220:221], v148 offset:34880
    ds_read_b64_tr_b16 v[222:223], v148 offset:35648
    s_waitcnt lgkmcnt(5)
    v_mfma_f32_32x32x16_bf16 v[168:183], v[228:231], v[28:31], v[168:183]
    v_mfma_f32_32x32x16_bf16 v[184:199], v[232:235], v[28:31], v[184:199]
    s_add_u32 s67, s14, 4
    s_and_b32 s67, s67, 7
    s_mul_i32 s67, s67, 196608
    s_add_u32 s67, s67, s64
    s_add_u32 m0, s66, 114688
    s_nop 0
    buffer_load_dwordx4 v154, s[16:19], s67 offen lds
    ds_read_b128 v[36:39], v139 offset:28672
    ds_read_b64_tr_b16 v[228:229], v148 offset:37888
    ds_read_b64_tr_b16 v[230:231], v148 offset:38656
    ds_read_b64_tr_b16 v[232:233], v148 offset:37952
    ds_read_b64_tr_b16 v[234:235], v148 offset:38720
    s_waitcnt lgkmcnt(5)
    v_mfma_f32_32x32x16_bf16 v[168:183], v[216:219], v[32:35], v[168:183]
    v_mfma_f32_32x32x16_bf16 v[184:199], v[220:223], v[32:35], v[184:199]
    s_add_u32 m0, s66, 115712
    s_nop 0
    buffer_load_dwordx4 v155, s[16:19], s67 offen lds
    s_waitcnt vmcnt(5) lgkmcnt(0)
    s_barrier
    ds_read_b128 v[40:43], v140 offset:0
    ds_read_b64_tr_b16 v[216:217], v149 offset:0
    ds_read_b64_tr_b16 v[218:219], v149 offset:768
    ds_read_b64_tr_b16 v[220:221], v149 offset:64
    ds_read_b64_tr_b16 v[222:223], v149 offset:832
    v_mfma_f32_32x32x16_bf16 v[168:183], v[228:231], v[36:39], v[168:183]
    v_mfma_f32_32x32x16_bf16 v[184:199], v[232:235], v[36:39], v[184:199]
    s_add_u32 m0, s66, 116736
    s_nop 0
    buffer_load_dwordx4 v156, s[16:19], s67 offen lds
    ds_read_b128 v[44:47], v141 offset:0
    ds_read_b64_tr_b16 v[228:229], v149 offset:3072
    ds_read_b64_tr_b16 v[230:231], v149 offset:3840
    ds_read_b64_tr_b16 v[232:233], v149 offset:3136
    ds_read_b64_tr_b16 v[234:235], v149 offset:3904
    s_waitcnt lgkmcnt(5)
    v_mfma_f32_32x32x16_bf16 v[168:183], v[216:219], v[40:43], v[168:183]
    v_mfma_f32_32x32x16_bf16 v[184:199], v[220:223], v[40:43], v[184:199]
    ds_read_b128 v[48:51], v142 offset:0
    ds_read_b64_tr_b16 v[216:217], v149 offset:6144
    ds_read_b64_tr_b16 v[218:219], v149 offset:6912
    ds_read_b64_tr_b16 v[220:221], v149 offset:6208
    ds_read_b64_tr_b16 v[222:223], v149 offset:6976
    s_waitcnt lgkmcnt(5)
    v_mfma_f32_32x32x16_bf16 v[168:183], v[228:231], v[44:47], v[168:183]
    v_mfma_f32_32x32x16_bf16 v[184:199], v[232:235], v[44:47], v[184:199]
    s_add_u32 s67, s14, 5
    s_and_b32 s67, s67, 7
    s_mul_i32 s67, s67, 196608
    s_add_u32 s67, s67, s64
    s_add_u32 m0, s66, 0
    s_nop 0
    buffer_load_dwordx4 v154, s[16:19], s67 offen lds
    ds_read_b128 v[52:55], v143 offset:0
    ds_read_b64_tr_b16 v[228:229], v149 offset:9216
    ds_read_b64_tr_b16 v[230:231], v149 offset:9984
    ds_read_b64_tr_b16 v[232:233], v149 offset:9280
    ds_read_b64_tr_b16 v[234:235], v149 offset:10048
    s_waitcnt lgkmcnt(5)
    v_mfma_f32_32x32x16_bf16 v[168:183], v[216:219], v[48:51], v[168:183]
    v_mfma_f32_32x32x16_bf16 v[184:199], v[220:223], v[48:51], v[184:199]
    s_add_u32 m0, s66, 1024
    s_nop 0
    buffer_load_dwordx4 v155, s[16:19], s67 offen lds
    s_waitcnt vmcnt(5) lgkmcnt(0)
    s_barrier
    ds_read_b128 v[56:59], v140 offset:28672
    ds_read_b64_tr_b16 v[216:217], v149 offset:28672
    ds_read_b64_tr_b16 v[218:219], v149 offset:29440
    ds_read_b64_tr_b16 v[220:221], v149 offset:28736
    ds_read_b64_tr_b16 v[222:223], v149 offset:29504
    v_mfma_f32_32x32x16_bf16 v[168:183], v[228:231], v[52:55], v[168:183]
    v_mfma_f32_32x32x16_bf16 v[184:199], v[232:235], v[52:55], v[184:199]
    s_add_u32 m0, s66, 2048
    s_nop 0
    buffer_load_dwordx4 v156, s[16:19], s67 offen lds
    ds_read_b128 v[60:63], v141 offset:28672
    ds_read_b64_tr_b16 v[228:229], v149 offset:31744
    ds_read_b64_tr_b16 v[230:231], v149 offset:32512
    ds_read_b64_tr_b16 v[232:233], v149 offset:31808
    ds_read_b64_tr_b16 v[234:235], v149 offset:32576
    s_waitcnt lgkmcnt(5)
    v_mfma_f32_32x32x16_bf16 v[168:183], v[216:219], v[56:59], v[168:183]
    v_mfma_f32_32x32x16_bf16 v[184:199], v[220:223], v[56:59], v[184:199]
    s_add_u32 s67, s14, 6
    s_and_b32 s67, s67, 7
    s_mul_i32 s67, s67, 196608
    s_add_u32 s67, s67, s64
    s_add_u32 m0, s66, 28672
    s_nop 0
    buffer_load_dwordx4 v154, s[16:19], s67 offen lds
    ds_read_b128 v[64:67], v142 offset:28672
    ds_read_b64_tr_b16 v[216:217], v149 offset:34816
    ds_read_b64_tr_b16 v[218:219], v149 offset:35584
    ds_read_b64_tr_b16 v[220:221], v149 offset:34880
    ds_read_b64_tr_b16 v[222:223], v149 offset:35648
    s_waitcnt lgkmcnt(5)
    v_mfma_f32_32x32x16_bf16 v[168:183], v[228:231], v[60:63], v[168:183]
    v_mfma_f32_32x32x16_bf16 v[184:199], v[232:235], v[60:63], v[184:199]
    s_add_u32 m0, s66, 29696
    s_nop 0
    buffer_load_dwordx4 v155, s[16:19], s67 offen lds
    ds_read_b128 v[68:71], v143 offset:28672
    ds_read_b64_tr_b16 v[228:229], v149 offset:37888
    ds_read_b64_tr_b16 v[230:231], v149 offset:38656
    ds_read_b64_tr_b16 v[232:233], v149 offset:37952
    ds_read_b64_tr_b16 v[234:235], v149 offset:38720
    s_waitcnt lgkmcnt(5)
    v_mfma_f32_32x32x16_bf16 v[168:183], v[216:219], v[64:67], v[168:183]
    v_mfma_f32_32x32x16_bf16 v[184:199], v[220:223], v[64:67], v[184:199]
    s_add_u32 m0, s66, 30720
    s_nop 0
    buffer_load_dwordx4 v156, s[16:19], s67 offen lds
    s_waitcnt vmcnt(6) lgkmcnt(0)
    s_barrier
    ds_read_b128 v[72:75], v144 offset:0
    ds_read_b64_tr_b16 v[216:217], v150 offset:0
    ds_read_b64_tr_b16 v[218:219], v150 offset:768
    ds_read_b64_tr_b16 v[220:221], v150 offset:64
    ds_read_b64_tr_b16 v[222:223], v150 offset:832
    v_mfma_f32_32x32x16_bf16 v[168:183], v[228:231], v[68:71], v[168:183]
    v_mfma_f32_32x32x16_bf16 v[184:199], v[232:235], v[68:71], v[184:199]
    s_add_u32 s67, s14, 7
    s_and_b32 s67, s67, 7
    s_mul_i32 s67, s67, 196608
    s_add_u32 s67, s67, s64
    s_add_u32 m0, s66, 57344
    s_nop 0
    buffer_load_dwordx4 v154, s[16:19], s67 offen lds
    ds_read_b128 v[76:79], v145 offset:0
    ds_read_b64_tr_b16 v[228:229], v150 offset:3072
    ds_read_b64_tr_b16 v[230:231], v150 offset:3840
    ds_read_b64_tr_b16 v[232:233], v150 offset:3136
    ds_read_b64_tr_b16 v[234:235], v150 offset:3904
    s_waitcnt lgkmcnt(5)
    v_mfma_f32_32x32x16_bf16 v[168:183], v[216:219], v[72:75], v[168:183]
    v_mfma_f32_32x32x16_bf16 v[184:199], v[220:223], v[72:75], v[184:199]
    s_add_u32 m0, s66, 58368
    s_nop 0
    buffer_load_dwordx4 v155, s[16:19], s67 offen lds
    ds_read_b128 v[80:83], v146 offset:0
    ds_read_b64_tr_b16 v[216:217], v150 offset:6144
    ds_read_b64_tr_b16 v[218:219], v150 offset:6912
    ds_read_b64_tr_b16 v[220:221], v150 offset:6208
    ds_read_b64_tr_b16 v[222:223], v150 offset:6976
    s_waitcnt lgkmcnt(5)
    v_mfma_f32_32x32x16_bf16 v[168:183], v[228:231], v[76:79], v[168:183]
    v_mfma_f32_32x32x16_bf16 v[184:199], v[232:235], v[76:79], v[184:199]
    s_add_u32 m0, s66, 59392
    s_nop 0
    buffer_load_dwordx4 v156, s[16:19], s67 offen lds
    ds_read_b128 v[84:87], v147 offset:0
    ds_read_b64_tr_b16 v[228:229], v150 offset:9216
    ds_read_b64_tr_b16 v[230:231], v150 offset:9984
    ds_read_b64_tr_b16 v[232:233], v150 offset:9280
    ds_read_b64_tr_b16 v[234:235], v150 offset:10048
    s_waitcnt lgkmcnt(5)
    v_mfma_f32_32x32x16_bf16 v[168:183], v[216:219], v[80:83], v[168:183]
    v_mfma_f32_32x32x16_bf16 v[184:199], v[220:223], v[80:83], v[184:199]
    s_add_u32 s67, s14, 8
    s_and_b32 s67, s67, 7
    s_mul_i32 s67, s67, 176128
    s_add_u32 s67, s67, s65
    s_add_u32 m0, s63, 86016
    s_nop 0
    buffer_load_dwordx4 v157, s[20:23], s67 offen lds
    s_waitcnt vmcnt(7) lgkmcnt(0)
    s_barrier
    ds_read_b128 v[88:91], v136 offset:0
    ds_read_b64_tr_b16 v[216:217], v148 offset:0
    ds_read_b64_tr_b16 v[218:219], v148 offset:768
    ds_read_b64_tr_b16 v[220:221], v148 offset:64
    ds_read_b64_tr_b16 v[222:223], v148 offset:832
    v_mfma_f32_32x32x16_bf16 v[168:183], v[228:231], v[84:87], v[168:183]
    v_mfma_f32_32x32x16_bf16 v[184:199], v[232:235], v[84:87], v[184:199]
    s_add_u32 m0, s63, 87040
    s_nop 0
    buffer_load_dwordx4 v158, s[20:23], s67 offen lds
    s_add_u32 m0, s63, 88064
    s_nop 0
    buffer_load_dwordx4 v159, s[20:23], s67 offen lds
    ds_read_b128 v[92:95], v137 offset:0
    ds_read_b64_tr_b16 v[228:229], v148 offset:3072
    ds_read_b64_tr_b16 v[230:231], v148 offset:3840
    ds_read_b64_tr_b16 v[232:233], v148 offset:3136
    ds_read_b64_tr_b16 v[234:235], v148 offset:3904
    s_waitcnt lgkmcnt(5)
    v_mfma_f32_32x32x16_bf16 v[168:183], v[216:219], v[88:91], v[168:183]
    v_mfma_f32_32x32x16_bf16 v[184:199], v[220:223], v[88:91], v[184:199]
    ds_read_b128 v[96:99], v138 offset:0
    ds_read_b64_tr_b16 v[216:217], v148 offset:6144
    ds_read_b64_tr_b16 v[218:219], v148 offset:6912
    ds_read_b64_tr_b16 v[220:221], v148 offset:6208
    ds_read_b64_tr_b16 v[222:223], v148 offset:6976
    s_waitcnt lgkmcnt(5)
    v_mfma_f32_32x32x16_bf16 v[168:183], v[228:231], v[92:95], v[168:183]
    v_mfma_f32_32x32x16_bf16 v[184:199], v[232:235], v[92:95], v[184:199]
    ds_read_b128 v[100:103], v139 offset:0
    ds_read_b64_tr_b16 v[228:229], v148 offset:9216
    ds_read_b64_tr_b16 v[230:231], v148 offset:9984
    ds_read_b64_tr_b16 v[232:233], v148 offset:9280
    ds_read_b64_tr_b16 v[234:235], v148 offset:10048
    s_waitcnt lgkmcnt(5)
    v_mfma_f32_32x32x16_bf16 v[168:183], v[216:219], v[96:99], v[168:183]
    v_mfma_f32_32x32x16_bf16 v[184:199], v[220:223], v[96:99], v[184:199]
    s_waitcnt vmcnt(6) lgkmcnt(0)
    s_barrier
    ds_read_b128 v[104:107], v136 offset:28672
    ds_read_b64_tr_b16 v[216:217], v148 offset:28672
    ds_read_b64_tr_b16 v[218:219], v148 offset:29440
    ds_read_b64_tr_b16 v[220:221], v148 offset:28736
    ds_read_b64_tr_b16 v[222:223], v148 offset:29504
    v_mfma_f32_32x32x16_bf16 v[168:183], v[228:231], v[100:103], v[168:183]
    v_mfma_f32_32x32x16_bf16 v[184:199], v[232:235], v[100:103], v[184:199]
    ds_read_b128 v[108:111], v137 offset:28672
    ds_read_b64_tr_b16 v[228:229], v148 offset:31744
    ds_read_b64_tr_b16 v[230:231], v148 offset:32512
    ds_read_b64_tr_b16 v[232:233], v148 offset:31808
    ds_read_b64_tr_b16 v[234:235], v148 offset:32576
    s_waitcnt lgkmcnt(5)
    v_mfma_f32_32x32x16_bf16 v[168:183], v[216:219], v[104:107], v[168:183]
    v_mfma_f32_32x32x16_bf16 v[184:199], v[220:223], v[104:107], v[184:199]
    ds_read_b128 v[112:115], v138 offset:28672
    ds_read_b64_tr_b16 v[216:217], v148 offset:34816
    ds_read_b64_tr_b16 v[218:219], v148 offset:35584
    ds_read_b64_tr_b16 v[220:221], v148 offset:34880
    ds_read_b64_tr_b16 v[222:223], v148 offset:35648
    s_waitcnt lgkmcnt(5)
    v_mfma_f32_32x32x16_bf16 v[168:183], v[228:231], v[108:111], v[168:183]
    v_mfma_f32_32x32x16_bf16 v[184:199], v[232:235], v[108:111], v[184:199]
    ds_read_b128 v[116:119], v139 offset:28672
    ds_read_b64_tr_b16 v[228:229], v148 offset:37888
    ds_read_b64_tr_b16 v[230:231], v148 offset:38656
    ds_read_b64_tr_b16 v[232:233], v148 offset:37952
    ds_read_b64_tr_b16 v[234:235], v148 offset:38720
    s_waitcnt lgkmcnt(5)
    v_mfma_f32_32x32x16_bf16 v[168:183], v[216:219], v[112:115], v[168:183]
    v_mfma_f32_32x32x16_bf16 v[184:199], v[220:223], v[112:115], v[184:199]
    s_add_u32 s67, s14, 9
    s_and_b32 s67, s67, 7
    s_mul_i32 s67, s67, 176128
    s_add_u32 s67, s67, s65
    s_add_u32 m0, s63, 114688
    s_nop 0
    buffer_load_dwordx4 v157, s[20:23], s67 offen lds
    s_waitcnt vmcnt(4) lgkmcnt(0)
    s_barrier
    ds_read_b128 v[120:123], v140 offset:0
    ds_read_b64_tr_b16 v[216:217], v149 offset:0
    ds_read_b64_tr_b16 v[218:219], v149 offset:768
    ds_read_b64_tr_b16 v[220:221], v149 offset:64
    ds_read_b64_tr_b16 v[222:223], v149 offset:832
    v_mfma_f32_32x32x16_bf16 v[168:183], v[228:231], v[116:119], v[168:183]
    v_mfma_f32_32x32x16_bf16 v[184:199], v[232:235], v[116:119], v[184:199]
    s_add_u32 m0, s63, 115712
    s_nop 0
    buffer_load_dwordx4 v158, s[20:23], s67 offen lds
    ds_read_b128 v[124:127], v141 offset:0
    ds_read_b64_tr_b16 v[228:229], v149 offset:3072
    ds_read_b64_tr_b16 v[230:231], v149 offset:3840
    ds_read_b64_tr_b16 v[232:233], v149 offset:3136
    ds_read_b64_tr_b16 v[234:235], v149 offset:3904
    s_waitcnt lgkmcnt(5)
    v_mfma_f32_32x32x16_bf16 v[168:183], v[216:219], v[120:123], v[168:183]
    v_mfma_f32_32x32x16_bf16 v[184:199], v[220:223], v[120:123], v[184:199]
    s_add_u32 m0, s63, 116736
    s_nop 0
    buffer_load_dwordx4 v159, s[20:23], s67 offen lds
    ds_read_b128 v[128:131], v142 offset:0
    ds_read_b64_tr_b16 v[216:217], v149 offset:6144
    ds_read_b64_tr_b16 v[218:219], v149 offset:6912
    ds_read_b64_tr_b16 v[220:221], v149 offset:6208
    ds_read_b64_tr_b16 v[222:223], v149 offset:6976
    s_waitcnt lgkmcnt(5)
    v_mfma_f32_32x32x16_bf16 v[168:183], v[228:231], v[124:127], v[168:183]
    v_mfma_f32_32x32x16_bf16 v[184:199], v[232:235], v[124:127], v[184:199]
    s_add_u32 s67, s14, 10
    s_and_b32 s67, s67, 7
    s_mul_i32 s67, s67, 176128
    s_add_u32 s67, s67, s65
    s_add_u32 m0, s63, 0
    s_nop 0
    buffer_load_dwordx4 v157, s[20:23], s67 offen lds
    ds_read_b128 v[132:135], v143 offset:0
    ds_read_b64_tr_b16 v[228:229], v149 offset:9216
    ds_read_b64_tr_b16 v[230:231], v149 offset:9984
    ds_read_b64_tr_b16 v[232:233], v149 offset:9280
    ds_read_b64_tr_b16 v[234:235], v149 offset:10048
    s_waitcnt lgkmcnt(5)
    v_mfma_f32_32x32x16_bf16 v[168:183], v[216:219], v[128:131], v[168:183]
    v_mfma_f32_32x32x16_bf16 v[184:199], v[220:223], v[128:131], v[184:199]
    s_add_u32 m0, s63, 1024
    s_nop 0
    buffer_load_dwordx4 v158, s[20:23], s67 offen lds
    s_waitcnt vmcnt(5) lgkmcnt(0)
    s_barrier
    ds_read_b64_tr_b16 v[216:217], v152 offset:28672
    ds_read_b64_tr_b16 v[218:219], v152 offset:29440
    ds_read_b64_tr_b16 v[220:221], v152 offset:28704
    ds_read_b64_tr_b16 v[222:223], v152 offset:29472
    ds_read_b64_tr_b16 v[224:225], v152 offset:28736
    ds_read_b64_tr_b16 v[226:227], v152 offset:29504
    v_mfma_f32_32x32x16_bf16 v[168:183], v[228:231], v[132:135], v[168:183]
    v_mfma_f32_32x32x16_bf16 v[184:199], v[232:235], v[132:135], v[184:199]
    s_add_u32 m0, s63, 2048
    s_nop 0
    buffer_load_dwordx4 v159, s[20:23], s67 offen lds
    s_lshl_b32 s69, s12, 2
    s_add_u32 s69, s69, s15
    s_lshl_b32 s70, s69, 10
    s_mov_b32 s72, 0x3eb8aa3b
    s_cmp_lt_u32 s13, 8
    s_cselect_b32 s72, s72, 1.0
    s_mov_b32 s73, s72
    s_lshl_b32 s71, s13, 18
    s_add_u32 s71, s71, s70
    v_pk_mul_f32 v[168:169], v[168:169], s[72:73]
    v_pk_mul_f32 v[170:171], v[170:171], s[72:73]
    v_pk_mul_f32 v[172:173], v[172:173], s[72:73]
    v_pk_mul_f32 v[174:175], v[174:175], s[72:73]
    v_pk_mul_f32 v[176:177], v[176:177], s[72:73]
    v_pk_mul_f32 v[178:179], v[178:179], s[72:73]
    v_pk_mul_f32 v[180:181], v[180:181], s[72:73]
    v_pk_mul_f32 v[182:183], v[182:183], s[72:73]
    v_cvt_pk_bf16_f32 v240, v168, v169
    v_cvt_pk_bf16_f32 v241, v170, v171
    v_cvt_pk_bf16_f32 v242, v172, v173
    v_cvt_pk_bf16_f32 v243, v174, v175
    buffer_store_dwordx4 v[240:243], v2, s[24:27], s71 offen sc1
    s_add_u32 s71, s71, 65536
    v_cvt_pk_bf16_f32 v244, v176, v177
    v_cvt_pk_bf16_f32 v245, v178, v179
    v_cvt_pk_bf16_f32 v246, v180, v181
    v_cvt_pk_bf16_f32 v247, v182, v183
    v_pk_mul_f32 v[184:185], v[184:185], s[72:73]
    v_pk_mul_f32 v[186:187], v[186:187], s[72:73]
    v_pk_mul_f32 v[188:189], v[188:189], s[72:73]
    v_pk_mul_f32 v[190:191], v[190:191], s[72:73]
    v_pk_mul_f32 v[192:193], v[192:193], s[72:73]
    v_pk_mul_f32 v[194:195], v[194:195], s[72:73]
    v_pk_mul_f32 v[196:197], v[196:197], s[72:73]
    v_pk_mul_f32 v[198:199], v[198:199], s[72:73]
    v_cvt_pk_bf16_f32 v248, v184, v185
    v_cvt_pk_bf16_f32 v249, v186, v187
    v_cvt_pk_bf16_f32 v250, v188, v189
    v_cvt_pk_bf16_f32 v251, v190, v191
    v_cvt_pk_bf16_f32 v252, v192, v193
    v_cvt_pk_bf16_f32 v253, v194, v195
    v_cvt_pk_bf16_f32 v254, v196, v197
    v_cvt_pk_bf16_f32 v255, v198, v199
    s_waitcnt lgkmcnt(0)
    ds_read_b64_tr_b16 v[228:229], v152 offset:31744
    ds_read_b64_tr_b16 v[230:231], v152 offset:32512
    ds_read_b64_tr_b16 v[232:233], v152 offset:31776
    ds_read_b64_tr_b16 v[234:235], v152 offset:32544
    ds_read_b64_tr_b16 v[236:237], v152 offset:31808
    ds_read_b64_tr_b16 v[238:239], v152 offset:32576
    s_waitcnt lgkmcnt(6)
    v_mfma_f32_32x32x16_bf16 v[168:183], v[216:219], v[8:11], 0
    v_mfma_f32_32x32x16_bf16 v[184:199], v[220:223], v[8:11], 0
    v_mfma_f32_32x32x16_bf16 v[200:215], v[224:227], v[8:11], 0
    buffer_store_dwordx4 v[244:247], v2, s[24:27], s71 offen sc1
    s_add_u32 s71, s71, 65536
    ds_read_b64_tr_b16 v[216:217], v152 offset:34816
    ds_read_b64_tr_b16 v[218:219], v152 offset:35584
    ds_read_b64_tr_b16 v[220:221], v152 offset:34848
    ds_read_b64_tr_b16 v[222:223], v152 offset:35616
    ds_read_b64_tr_b16 v[224:225], v152 offset:34880
    ds_read_b64_tr_b16 v[226:227], v152 offset:35648
    s_waitcnt lgkmcnt(6)
    v_mfma_f32_32x32x16_bf16 v[168:183], v[228:231], v[12:15], v[168:183]
    v_mfma_f32_32x32x16_bf16 v[184:199], v[232:235], v[12:15], v[184:199]
    v_mfma_f32_32x32x16_bf16 v[200:215], v[236:239], v[12:15], v[200:215]
    buffer_store_dwordx4 v[248:251], v2, s[24:27], s71 offen sc1
    s_add_u32 s71, s71, 65536
    s_add_u32 s67, s14, 11
    s_and_b32 s67, s67, 7
    s_mul_i32 s67, s67, 176128
    s_add_u32 s67, s67, s65
    s_add_u32 m0, s63, 28672
    s_nop 0
    buffer_load_dwordx4 v157, s[20:23], s67 offen lds
    s_and_b32 s30, s2, 7
    s_lshr_b32 s31, s2, 3
    s_lshl_b32 s4, s30, 2
    s_lshr_b32 s32, s31, 3
    s_add_u32 s4, s4, s32
    s_and_b32 s5, s31, 7
    s_and_b32 s38, s3, 3
    s_lshr_b32 s39, s3, 2
    s_lshl_b32 s33, s4, 16
    s_lshl_b32 s6, s5, 13
    s_add_u32 s6, s6, s33
    s_lshl_b32 s7, s38, 1
    s_lshl_b32 s8, s3, 13
    s_add_u32 s8, s8, s33
    s_add_u32 s9, s8, 4194304
    s_add_u32 s8, s8, 2097152
    s_add_u32 s10, s8, 4096
    s_add_u32 s11, s9, 4096
    s_add_u32 s35, s7, 7
    s_and_b32 s35, s35, 7
    s_xor_b32 s35, s35, s39
    s_lshl_b32 s36, s5, 3
    s_add_u32 s35, s35, s36
    s_mov_b32 s74, 0xffff
    s_mov_b32 s75, 0xffff
    ds_read_b64_tr_b16 v[228:229], v152 offset:37888
    ds_read_b64_tr_b16 v[230:231], v152 offset:38656
    ds_read_b64_tr_b16 v[232:233], v152 offset:37920
    ds_read_b64_tr_b16 v[234:235], v152 offset:38688
    ds_read_b64_tr_b16 v[236:237], v152 offset:37952
    ds_read_b64_tr_b16 v[238:239], v152 offset:38720
    s_waitcnt lgkmcnt(6)
    v_mfma_f32_32x32x16_bf16 v[168:183], v[216:219], v[16:19], v[168:183]
    v_mfma_f32_32x32x16_bf16 v[184:199], v[220:223], v[16:19], v[184:199]
    v_mfma_f32_32x32x16_bf16 v[200:215], v[224:227], v[16:19], v[200:215]
    buffer_store_dwordx4 v[252:255], v2, s[24:27], s71 offen sc1
    s_add_u32 s71, s71, 65536
    s_add_u32 m0, s63, 29696
    s_nop 0
    buffer_load_dwordx4 v158, s[20:23], s67 offen lds
    v_lshrrev_b32 v136, 5, v1
    v_and_b32 v137, 15, v1
    v_lshl_add_u32 v3, v136, 4, v137
    v_lshlrev_b32 v3, 4, v3
    v_and_b32 v136, 27, v1
    v_cmp_eq_u32 vcc, 16, v136
    v_and_b32 v6, 31, v1
    v_lshlrev_b32 v6, 2, v6
    v_mov_b32 v136, 0x3f803f80
    v_cndmask_b32 v136, 0, v136, vcc
    v_lshlrev_b32 v138, 2, v137
    v_mov_b32 v137, v136
    s_lshr_b32 s30, s4, 2
    s_lshl_b32 s30, s30, 7
    s_lshr_b32 s31, s4, 1
    s_lshl_b32 s31, s31, 7
    v_and_b32 v139, 16, v1
    v_lshl_add_u32 v139, v139, 6, s30
    v_cmp_gt_u32 vcc, 32, v1
    v_mov_b32 v140, s31
    s_lshl_b32 s36, s35, 7
    v_cndmask_b32 v139, v140, v139, vcc
    v_add_u32 v138, v138, v139
    s_lshl_b32 s30, s30, 6
    s_add_u32 s36, s36, s30
    s_add_u32 s36, s36, 14680064
    s_mov_b32 s60, 14745600
    s_waitcnt vmcnt(9) lgkmcnt(0)
    s_barrier
    ds_read_b64_tr_b16 v[216:217], v153 offset:0
    ds_read_b64_tr_b16 v[218:219], v153 offset:768
    ds_read_b64_tr_b16 v[220:221], v153 offset:32
    ds_read_b64_tr_b16 v[222:223], v153 offset:800
    ds_read_b64_tr_b16 v[224:225], v153 offset:64
    ds_read_b64_tr_b16 v[226:227], v153 offset:832
    v_mfma_f32_32x32x16_bf16 v[168:183], v[228:231], v[20:23], v[168:183]
    v_mfma_f32_32x32x16_bf16 v[184:199], v[232:235], v[20:23], v[184:199]
    v_mfma_f32_32x32x16_bf16 v[200:215], v[236:239], v[20:23], v[200:215]
    s_add_u32 m0, s63, 30720
    s_nop 0
    buffer_load_dwordx4 v159, s[20:23], s67 offen lds
    s_and_b32 s59, s2, 7
    s_lshr_b32 s53, s2, 3
    s_lshl_b32 s52, s59, 2
    s_and_b32 s59, s53, 3
    s_add_u32 s52, s52, s59
    s_lshr_b32 s53, s53, 2
    s_and_b32 s54, s3, 3
    s_lshr_b32 s55, s3, 2
    s_lshl_b32 s52, s52, 1
    s_add_u32 s52, s52, s55
    s_mul_i32 s56, s52, 86
    s_add_u32 s56, s56, s54
    s_lshl_b32 s56, s56, 10
    s_add_u32 s56, s56, 8388608
    s_lshl_b32 s57, s54, 14
    s_lshl_b32 s59, s55, 13
    s_add_u32 s57, s57, s59
    s_lshl_b32 s59, s53, 7
    s_add_u32 s57, s57, s59
    s_mul_i32 s58, s54, 10240
    s_lshl_b32 s59, s55, 10
    s_add_u32 s58, s58, s59
    v_lshrrev_b32 v140, 7, v2
    v_lshrrev_b32 v141, 3, v2
    v_and_b32 v141, 32, v141
    v_xor_b32 v141, v141, v2
    v_and_b32 v141, 0x70, v141
    v_lshl_add_u32 v1, v140, 10, v141
    ds_read_b64_tr_b16 v[228:229], v153 offset:3072
    ds_read_b64_tr_b16 v[230:231], v153 offset:3840
    ds_read_b64_tr_b16 v[232:233], v153 offset:3104
    ds_read_b64_tr_b16 v[234:235], v153 offset:3872
    ds_read_b64_tr_b16 v[236:237], v153 offset:3136
    ds_read_b64_tr_b16 v[238:239], v153 offset:3904
    s_waitcnt lgkmcnt(6)
    v_mfma_f32_32x32x16_bf16 v[168:183], v[216:219], v[24:27], v[168:183]
    v_mfma_f32_32x32x16_bf16 v[184:199], v[220:223], v[24:27], v[184:199]
    v_mfma_f32_32x32x16_bf16 v[200:215], v[224:227], v[24:27], v[200:215]
    s_add_u32 s67, s14, 12
    s_and_b32 s67, s67, 7
    s_mul_i32 s67, s67, 176128
    s_add_u32 s67, s67, s65
    s_add_u32 m0, s63, 57344
    s_nop 0
    buffer_load_dwordx4 v157, s[20:23], s67 offen lds
    s_lshl_b32 s68, s15, 7
    s_add_u32 s68, s68, 144384
    v_lshl_add_u32 v7, v5, 2, s68
    ds_read_b32 v0, v7
    ds_read_b64_tr_b16 v[216:217], v153 offset:6144
    ds_read_b64_tr_b16 v[218:219], v153 offset:6912
    ds_read_b64_tr_b16 v[220:221], v153 offset:6176
    ds_read_b64_tr_b16 v[222:223], v153 offset:6944
    ds_read_b64_tr_b16 v[224:225], v153 offset:6208
    ds_read_b64_tr_b16 v[226:227], v153 offset:6976
    s_waitcnt lgkmcnt(6)
    v_mfma_f32_32x32x16_bf16 v[168:183], v[228:231], v[28:31], v[168:183]
    v_mfma_f32_32x32x16_bf16 v[184:199], v[232:235], v[28:31], v[184:199]
    v_mfma_f32_32x32x16_bf16 v[200:215], v[236:239], v[28:31], v[200:215]
    s_add_u32 m0, s63, 58368
    s_nop 0
    buffer_load_dwordx4 v158, s[20:23], s67 offen lds
    ds_read_b64_tr_b16 v[228:229], v153 offset:9216
    ds_read_b64_tr_b16 v[230:231], v153 offset:9984
    ds_read_b64_tr_b16 v[232:233], v153 offset:9248
    ds_read_b64_tr_b16 v[234:235], v153 offset:10016
    ds_read_b64_tr_b16 v[236:237], v153 offset:9280
    ds_read_b64_tr_b16 v[238:239], v153 offset:10048
    s_waitcnt lgkmcnt(6)
    v_mfma_f32_32x32x16_bf16 v[168:183], v[216:219], v[32:35], v[168:183]
    v_mfma_f32_32x32x16_bf16 v[184:199], v[220:223], v[32:35], v[184:199]
    v_mfma_f32_32x32x16_bf16 v[200:215], v[224:227], v[32:35], v[200:215]
    s_add_u32 m0, s63, 59392
    s_nop 0
    buffer_load_dwordx4 v159, s[20:23], s67 offen lds
    s_waitcnt vmcnt(5)
    s_waitcnt lgkmcnt(0)
    s_barrier
    ds_read_b64_tr_b16 v[216:217], v151 offset:0
    ds_read_b64_tr_b16 v[218:219], v151 offset:768
    ds_read_b64_tr_b16 v[220:221], v151 offset:32
    ds_read_b64_tr_b16 v[222:223], v151 offset:800
    ds_read_b64_tr_b16 v[224:225], v151 offset:64
    ds_read_b64_tr_b16 v[226:227], v151 offset:832
    v_mfma_f32_32x32x16_bf16 v[168:183], v[228:231], v[36:39], v[168:183]
    v_mfma_f32_32x32x16_bf16 v[184:199], v[232:235], v[36:39], v[184:199]
    v_mfma_f32_32x32x16_bf16 v[200:215], v[236:239], v[36:39], v[200:215]
    s_add_u32 s67, s14, 13
    s_and_b32 s67, s67, 7
    s_mul_i32 s67, s67, 176128
    s_add_u32 s67, s67, s65
    s_add_u32 m0, s63, 86016
    s_nop 0
    buffer_load_dwordx4 v157, s[20:23], s67 offen lds
    s_cmp_lg_u32 s3, 0
    s_cbranch_scc1 nopost_6
    s_lshl_b32 s30, s13, 7
    s_lshl_b32 s31, s12, 2
    s_add_u32 s30, s30, s31
    s_add_u32 s30, s30, 14745600
    v_mov_b32 v140, s100
    s_mov_b64 exec, 1
    buffer_store_dword v140, off, s[24:27], s30 sc1
    s_mov_b64 exec, -1
nopost_6:
    ds_read_b64_tr_b16 v[228:229], v151 offset:3072
    ds_read_b64_tr_b16 v[230:231], v151 offset:3840
    ds_read_b64_tr_b16 v[232:233], v151 offset:3104
    ds_read_b64_tr_b16 v[234:235], v151 offset:3872
    ds_read_b64_tr_b16 v[236:237], v151 offset:3136
    ds_read_b64_tr_b16 v[238:239], v151 offset:3904
    s_waitcnt lgkmcnt(6)
    v_mfma_f32_32x32x16_bf16 v[168:183], v[216:219], v[40:43], v[168:183]
    v_mfma_f32_32x32x16_bf16 v[184:199], v[220:223], v[40:43], v[184:199]
    v_mfma_f32_32x32x16_bf16 v[200:215], v[224:227], v[40:43], v[200:215]
    s_add_u32 m0, s63, 87040
    s_nop 0
    buffer_load_dwordx4 v158, s[20:23], s67 offen lds
    ds_read_b64_tr_b16 v[216:217], v151 offset:6144
    ds_read_b64_tr_b16 v[218:219], v151 offset:6912
    ds_read_b64_tr_b16 v[220:221], v151 offset:6176
    ds_read_b64_tr_b16 v[222:223], v151 offset:6944
    ds_read_b64_tr_b16 v[224:225], v151 offset:6208
    ds_read_b64_tr_b16 v[226:227], v151 offset:6976
    s_waitcnt lgkmcnt(6)
    v_mfma_f32_32x32x16_bf16 v[168:183], v[228:231], v[44:47], v[168:183]
    v_mfma_f32_32x32x16_bf16 v[184:199], v[232:235], v[44:47], v[184:199]
    v_mfma_f32_32x32x16_bf16 v[200:215], v[236:239], v[44:47], v[200:215]
    s_add_u32 m0, s63, 88064
    s_nop 0
    buffer_load_dwordx4 v159, s[20:23], s67 offen lds
    ds_read_b64_tr_b16 v[228:229], v151 offset:9216
    ds_read_b64_tr_b16 v[230:231], v151 offset:9984
    ds_read_b64_tr_b16 v[232:233], v151 offset:9248
    ds_read_b64_tr_b16 v[234:235], v151 offset:10016
    ds_read_b64_tr_b16 v[236:237], v151 offset:9280
    ds_read_b64_tr_b16 v[238:239], v151 offset:10048
    s_waitcnt lgkmcnt(6)
    v_mfma_f32_32x32x16_bf16 v[168:183], v[216:219], v[48:51], v[168:183]
    v_mfma_f32_32x32x16_bf16 v[184:199], v[220:223], v[48:51], v[184:199]
    v_mfma_f32_32x32x16_bf16 v[200:215], v[224:227], v[48:51], v[200:215]
    s_add_u32 s67, s14, 14
    s_and_b32 s67, s67, 7
    s_mul_i32 s67, s67, 176128
    s_add_u32 s67, s67, s65
    s_add_u32 m0, s63, 114688
    s_nop 0
    buffer_load_dwordx4 v157, s[20:23], s67 offen lds
    s_lshl_b32 s70, s69, 5
    s_add_u32 s70, s70, s13
    s_lshl_b32 s62, s70, 3
    s_add_u32 s62, s62, 14749696
    s_lshl_b32 s70, s35, 6
    s_add_u32 s70, s70, s4
    s_lshl_b32 s28, s70, 2
    s_add_u32 s28, s28, 14749824
    s_lshl_b32 s70, s35, 5
    s_add_u32 s70, s70, s4
    s_lshl_b32 s70, s70, 10
    s_add_u32 s70, s70, 6291456
    v_mov_b64 v[160:161], -1
    v_mov_b64 v[162:163], -1
    buffer_store_dwordx4 v[160:163], v2, s[24:27], s70 offen sc1
    s_waitcnt vmcnt(8) lgkmcnt(0)
    s_barrier
    ds_read_b64_tr_b16 v[216:217], v151 offset:28672
    ds_read_b64_tr_b16 v[218:219], v151 offset:29440
    ds_read_b64_tr_b16 v[220:221], v151 offset:28704
    ds_read_b64_tr_b16 v[222:223], v151 offset:29472
    ds_read_b64_tr_b16 v[224:225], v151 offset:28736
    ds_read_b64_tr_b16 v[226:227], v151 offset:29504
    v_mfma_f32_32x32x16_bf16 v[168:183], v[228:231], v[52:55], v[168:183]
    v_mfma_f32_32x32x16_bf16 v[184:199], v[232:235], v[52:55], v[184:199]
    v_mfma_f32_32x32x16_bf16 v[200:215], v[236:239], v[52:55], v[200:215]
    s_add_u32 m0, s63, 115712
    s_nop 0
    buffer_load_dwordx4 v158, s[20:23], s67 offen lds
    ds_read_b64_tr_b16 v[228:229], v151 offset:31744
    ds_read_b64_tr_b16 v[230:231], v151 offset:32512
    ds_read_b64_tr_b16 v[232:233], v151 offset:31776
    ds_read_b64_tr_b16 v[234:235], v151 offset:32544
    ds_read_b64_tr_b16 v[236:237], v151 offset:31808
    ds_read_b64_tr_b16 v[238:239], v151 offset:32576
    s_waitcnt lgkmcnt(6)
    v_mfma_f32_32x32x16_bf16 v[168:183], v[216:219], v[56:59], v[168:183]
    v_mfma_f32_32x32x16_bf16 v[184:199], v[220:223], v[56:59], v[184:199]
    v_mfma_f32_32x32x16_bf16 v[200:215], v[224:227], v[56:59], v[200:215]
    s_add_u32 m0, s63, 116736
    s_nop 0
    buffer_load_dwordx4 v159, s[20:23], s67 offen lds
    ds_read_b64_tr_b16 v[216:217], v151 offset:34816
    ds_read_b64_tr_b16 v[218:219], v151 offset:35584
    ds_read_b64_tr_b16 v[220:221], v151 offset:34848
    ds_read_b64_tr_b16 v[222:223], v151 offset:35616
    ds_read_b64_tr_b16 v[224:225], v151 offset:34880
    ds_read_b64_tr_b16 v[226:227], v151 offset:35648
    s_waitcnt lgkmcnt(6)
    v_mfma_f32_32x32x16_bf16 v[168:183], v[228:231], v[60:63], v[168:183]
    v_mfma_f32_32x32x16_bf16 v[184:199], v[232:235], v[60:63], v[184:199]
    v_mfma_f32_32x32x16_bf16 v[200:215], v[236:239], v[60:63], v[200:215]
    s_add_u32 s67, s14, 15
    s_and_b32 s67, s67, 7
    s_mul_i32 s67, s67, 176128
    s_add_u32 s67, s67, s65
    s_add_u32 m0, s63, 0
    s_nop 0
    buffer_load_dwordx4 v157, s[20:23], s67 offen lds
    ds_read_b64_tr_b16 v[228:229], v151 offset:37888
    ds_read_b64_tr_b16 v[230:231], v151 offset:38656
    ds_read_b64_tr_b16 v[232:233], v151 offset:37920
    ds_read_b64_tr_b16 v[234:235], v151 offset:38688
    ds_read_b64_tr_b16 v[236:237], v151 offset:37952
    ds_read_b64_tr_b16 v[238:239], v151 offset:38720
    s_waitcnt lgkmcnt(6)
    v_mfma_f32_32x32x16_bf16 v[168:183], v[216:219], v[64:67], v[168:183]
    v_mfma_f32_32x32x16_bf16 v[184:199], v[220:223], v[64:67], v[184:199]
    v_mfma_f32_32x32x16_bf16 v[200:215], v[224:227], v[64:67], v[200:215]
    s_add_u32 m0, s63, 1024
    s_nop 0
    buffer_load_dwordx4 v158, s[20:23], s67 offen lds
    s_waitcnt vmcnt(9) lgkmcnt(0)
    s_barrier
    ds_read_b64_tr_b16 v[216:217], v152 offset:0
    ds_read_b64_tr_b16 v[218:219], v152 offset:768
    ds_read_b64_tr_b16 v[220:221], v152 offset:32
    ds_read_b64_tr_b16 v[222:223], v152 offset:800
    ds_read_b64_tr_b16 v[224:225], v152 offset:64
    ds_read_b64_tr_b16 v[226:227], v152 offset:832
    v_mfma_f32_32x32x16_bf16 v[168:183], v[228:231], v[68:71], v[168:183]
    v_mfma_f32_32x32x16_bf16 v[184:199], v[232:235], v[68:71], v[184:199]
    v_mfma_f32_32x32x16_bf16 v[200:215], v[236:239], v[68:71], v[200:215]
    s_add_u32 m0, s63, 2048
    s_nop 0
    buffer_load_dwordx4 v159, s[20:23], s67 offen lds
    ds_read_b64_tr_b16 v[228:229], v152 offset:3072
    ds_read_b64_tr_b16 v[230:231], v152 offset:3840
    ds_read_b64_tr_b16 v[232:233], v152 offset:3104
    ds_read_b64_tr_b16 v[234:235], v152 offset:3872
    ds_read_b64_tr_b16 v[236:237], v152 offset:3136
    ds_read_b64_tr_b16 v[238:239], v152 offset:3904
    s_waitcnt lgkmcnt(6)
    v_mfma_f32_32x32x16_bf16 v[168:183], v[216:219], v[72:75], v[168:183]
    v_mfma_f32_32x32x16_bf16 v[184:199], v[220:223], v[72:75], v[184:199]
    v_mfma_f32_32x32x16_bf16 v[200:215], v[224:227], v[72:75], v[200:215]
    buffer_load_dword v139, v138, s[24:27], s60 offen sc1
    ds_read_b64_tr_b16 v[216:217], v152 offset:6144
    ds_read_b64_tr_b16 v[218:219], v152 offset:6912
    ds_read_b64_tr_b16 v[220:221], v152 offset:6176
    ds_read_b64_tr_b16 v[222:223], v152 offset:6944
    ds_read_b64_tr_b16 v[224:225], v152 offset:6208
    ds_read_b64_tr_b16 v[226:227], v152 offset:6976
    s_waitcnt lgkmcnt(6)
    v_mfma_f32_32x32x16_bf16 v[168:183], v[228:231], v[76:79], v[168:183]
    v_mfma_f32_32x32x16_bf16 v[184:199], v[232:235], v[76:79], v[184:199]
    v_mfma_f32_32x32x16_bf16 v[200:215], v[236:239], v[76:79], v[200:215]
    ds_read_b64_tr_b16 v[228:229], v152 offset:9216
    ds_read_b64_tr_b16 v[230:231], v152 offset:9984
    ds_read_b64_tr_b16 v[232:233], v152 offset:9248
    ds_read_b64_tr_b16 v[234:235], v152 offset:10016
    ds_read_b64_tr_b16 v[236:237], v152 offset:9280
    ds_read_b64_tr_b16 v[238:239], v152 offset:10048
    s_waitcnt lgkmcnt(6)
    v_mfma_f32_32x32x16_bf16 v[168:183], v[216:219], v[80:83], v[168:183]
    v_mfma_f32_32x32x16_bf16 v[184:199], v[220:223], v[80:83], v[184:199]
    v_mfma_f32_32x32x16_bf16 v[200:215], v[224:227], v[80:83], v[200:215]
    s_waitcnt vmcnt(1) lgkmcnt(0)
    s_barrier
    s_setprio 2
    ds_read_b64_tr_b16 v[216:217], v152 offset:28672
    ds_read_b64_tr_b16 v[218:219], v152 offset:29440
    ds_read_b64_tr_b16 v[220:221], v152 offset:28704
    ds_read_b64_tr_b16 v[222:223], v152 offset:29472
    ds_read_b64_tr_b16 v[224:225], v152 offset:28736
    ds_read_b64_tr_b16 v[226:227], v152 offset:29504
    v_mfma_f32_32x32x16_bf16 v[168:183], v[228:231], v[84:87], v[168:183]
    v_mfma_f32_32x32x16_bf16 v[184:199], v[232:235], v[84:87], v[184:199]
    v_mfma_f32_32x32x16_bf16 v[200:215], v[236:239], v[84:87], v[200:215]
    ds_read_b64_tr_b16 v[228:229], v152 offset:31744
    ds_read_b64_tr_b16 v[230:231], v152 offset:32512
    ds_read_b64_tr_b16 v[232:233], v152 offset:31776
    ds_read_b64_tr_b16 v[234:235], v152 offset:32544
    ds_read_b64_tr_b16 v[236:237], v152 offset:31808
    ds_read_b64_tr_b16 v[238:239], v152 offset:32576
    s_waitcnt lgkmcnt(6)
    v_mfma_f32_32x32x16_bf16 v[168:183], v[216:219], v[88:91], v[168:183]
    v_mfma_f32_32x32x16_bf16 v[184:199], v[220:223], v[88:91], v[184:199]
    v_mfma_f32_32x32x16_bf16 v[200:215], v[224:227], v[88:91], v[200:215]
    s_waitcnt vmcnt(0)
    v_cmp_ne_u32 vcc, s100, v139
    s_cbranch_vccnz retry_7
back_8:
    buffer_load_dword v6, v6, s[24:27], s36 offen sc1
    s_add_u32 s34, s7, 0
    s_and_b32 s34, s34, 7
    s_xor_b32 s34, s34, s39
    s_lshl_b32 s34, s34, 10
    s_add_u32 s34, s34, s6
    buffer_load_dwordx4 v[160:163], v2, s[24:27], s34 offen sc1
    buffer_load_dwordx4 v[8:11], v2, s[24:27], s8 offen offset:0 sc1
    buffer_load_dwordx4 v[12:15], v2, s[24:27], s8 offen offset:1024 sc1
    ds_read_b64_tr_b16 v[216:217], v152 offset:34816
    ds_read_b64_tr_b16 v[218:219], v152 offset:35584
    ds_read_b64_tr_b16 v[220:221], v152 offset:34848
    ds_read_b64_tr_b16 v[222:223], v152 offset:35616
    ds_read_b64_tr_b16 v[224:225], v152 offset:34880
    ds_read_b64_tr_b16 v[226:227], v152 offset:35648
    s_waitcnt lgkmcnt(6)
    v_mfma_f32_32x32x16_bf16 v[168:183], v[228:231], v[92:95], v[168:183]
    v_mfma_f32_32x32x16_bf16 v[184:199], v[232:235], v[92:95], v[184:199]
    v_mfma_f32_32x32x16_bf16 v[200:215], v[236:239], v[92:95], v[200:215]
    v_mov_b64 v[40:41], v[136:137]
    v_mov_b64 v[42:43], v[136:137]
    v_mov_b64 v[44:45], v[136:137]
    v_mov_b64 v[46:47], v[136:137]
    s_mov_b64 exec, s[74:75]
    buffer_load_dwordx4 v[40:43], v3, s[24:27], s9 offen offset:0 sc1
    buffer_load_dwordx4 v[44:47], v3, s[24:27], s9 offen offset:512 sc1
    s_mov_b64 exec, -1
    buffer_load_dwordx4 v[16:19], v2, s[24:27], s8 offen offset:2048 sc1
    ds_read_b64_tr_b16 v[228:229], v152 offset:37888
    ds_read_b64_tr_b16 v[230:231], v152 offset:38656
    ds_read_b64_tr_b16 v[232:233], v152 offset:37920
    ds_read_b64_tr_b16 v[234:235], v152 offset:38688
    ds_read_b64_tr_b16 v[236:237], v152 offset:37952
    ds_read_b64_tr_b16 v[238:239], v152 offset:38720
    s_waitcnt lgkmcnt(6)
    v_mfma_f32_32x32x16_bf16 v[168:183], v[216:219], v[96:99], v[168:183]
    v_mfma_f32_32x32x16_bf16 v[184:199], v[220:223], v[96:99], v[184:199]
    v_mfma_f32_32x32x16_bf16 v[200:215], v[224:227], v[96:99], v[200:215]
    v_mov_b64 v[48:49], v[136:137]
    v_mov_b64 v[50:51], v[136:137]
    v_mov_b64 v[52:53], v[136:137]
    v_mov_b64 v[54:55], v[136:137]
    s_mov_b64 exec, s[74:75]
    buffer_load_dwordx4 v[48:51], v3, s[24:27], s9 offen offset:1024 sc1
    buffer_load_dwordx4 v[52:55], v3, s[24:27], s9 offen offset:1536 sc1
    s_mov_b64 exec, -1
    buffer_load_dwordx4 v[20:23], v2, s[24:27], s8 offen offset:3072 sc1
    ds_read_b64_tr_b16 v[216:217], v153 offset:0
    ds_read_b64_tr_b16 v[218:219], v153 offset:768
    ds_read_b64_tr_b16 v[220:221], v153 offset:32
    ds_read_b64_tr_b16 v[222:223], v153 offset:800
    ds_read_b64_tr_b16 v[224:225], v153 offset:64
    ds_read_b64_tr_b16 v[226:227], v153 offset:832
    s_waitcnt lgkmcnt(6)
    v_mfma_f32_32x32x16_bf16 v[168:183], v[228:231], v[100:103], v[168:183]
    v_mfma_f32_32x32x16_bf16 v[184:199], v[232:235], v[100:103], v[184:199]
    v_mfma_f32_32x32x16_bf16 v[200:215], v[236:239], v[100:103], v[200:215]
    v_mov_b64 v[56:57], v[136:137]
    v_mov_b64 v[58:59], v[136:137]
    v_mov_b64 v[60:61], v[136:137]
    v_mov_b64 v[62:63], v[136:137]
    s_mov_b64 exec, s[74:75]
    buffer_load_dwordx4 v[56:59], v3, s[24:27], s9 offen offset:2048 sc1
    buffer_load_dwordx4 v[60:63], v3, s[24:27], s9 offen offset:2560 sc1
    s_mov_b64 exec, -1
    buffer_load_dwordx4 v[24:27], v2, s[24:27], s10 offen offset:0 sc1
    ds_read_b64_tr_b16 v[228:229], v153 offset:3072
    ds_read_b64_tr_b16 v[230:231], v153 offset:3840
    ds_read_b64_tr_b16 v[232:233], v153 offset:3104
    ds_read_b64_tr_b16 v[234:235], v153 offset:3872
    ds_read_b64_tr_b16 v[236:237], v153 offset:3136
    ds_read_b64_tr_b16 v[238:239], v153 offset:3904
    s_waitcnt lgkmcnt(6)
    v_mfma_f32_32x32x16_bf16 v[168:183], v[216:219], v[104:107], v[168:183]
    v_mfma_f32_32x32x16_bf16 v[184:199], v[220:223], v[104:107], v[184:199]
    v_mfma_f32_32x32x16_bf16 v[200:215], v[224:227], v[104:107], v[200:215]
    v_mov_b64 v[64:65], v[136:137]
    v_mov_b64 v[66:67], v[136:137]
    v_mov_b64 v[68:69], v[136:137]
    v_mov_b64 v[70:71], v[136:137]
    s_mov_b64 exec, s[74:75]
    buffer_load_dwordx4 v[64:67], v3, s[24:27], s9 offen offset:3072 sc1
    buffer_load_dwordx4 v[68:71], v3, s[24:27], s9 offen offset:3584 sc1
    s_mov_b64 exec, -1
    buffer_load_dwordx4 v[28:31], v2, s[24:27], s10 offen offset:1024 sc1
    v_mov_b64 v[72:73], v[136:137]
    v_mov_b64 v[74:75], v[136:137]
    v_mov_b64 v[76:77], v[136:137]
    v_mov_b64 v[78:79], v[136:137]
    s_mov_b64 exec, s[74:75]
    buffer_load_dwordx4 v[72:75], v3, s[24:27], s11 offen offset:0 sc1
    buffer_load_dwordx4 v[76:79], v3, s[24:27], s11 offen offset:512 sc1
    s_mov_b64 exec, -1
    ds_read_b64_tr_b16 v[216:217], v153 offset:6144
    ds_read_b64_tr_b16 v[218:219], v153 offset:6912
    ds_read_b64_tr_b16 v[220:221], v153 offset:6176
    ds_read_b64_tr_b16 v[222:223], v153 offset:6944
    ds_read_b64_tr_b16 v[224:225], v153 offset:6208
    ds_read_b64_tr_b16 v[226:227], v153 offset:6976
    s_waitcnt lgkmcnt(6)
    v_mfma_f32_32x32x16_bf16 v[168:183], v[228:231], v[108:111], v[168:183]
    v_mfma_f32_32x32x16_bf16 v[184:199], v[232:235], v[108:111], v[184:199]
    v_mfma_f32_32x32x16_bf16 v[200:215], v[236:239], v[108:111], v[200:215]
    buffer_load_dwordx4 v[32:35], v2, s[24:27], s10 offen offset:2048 sc1
    v_mov_b64 v[80:81], v[136:137]
    v_mov_b64 v[82:83], v[136:137]
    v_mov_b64 v[84:85], v[136:137]
    v_mov_b64 v[86:87], v[136:137]
    s_mov_b64 exec, s[74:75]
    buffer_load_dwordx4 v[80:83], v3, s[24:27], s11 offen offset:1024 sc1
    buffer_load_dwordx4 v[84:87], v3, s[24:27], s11 offen offset:1536 sc1
    s_mov_b64 exec, -1
    ds_read_b64_tr_b16 v[228:229], v153 offset:9216
    ds_read_b64_tr_b16 v[230:231], v153 offset:9984
    ds_read_b64_tr_b16 v[232:233], v153 offset:9248
    ds_read_b64_tr_b16 v[234:235], v153 offset:10016
    ds_read_b64_tr_b16 v[236:237], v153 offset:9280
    ds_read_b64_tr_b16 v[238:239], v153 offset:10048
    s_waitcnt lgkmcnt(6)
    v_mfma_f32_32x32x16_bf16 v[168:183], v[216:219], v[112:115], v[168:183]
    v_mfma_f32_32x32x16_bf16 v[184:199], v[220:223], v[112:115], v[184:199]
    v_mfma_f32_32x32x16_bf16 v[200:215], v[224:227], v[112:115], v[200:215]
    buffer_load_dwordx4 v[36:39], v2, s[24:27], s10 offen offset:3072 sc1
    v_mov_b64 v[88:89], v[136:137]
    v_mov_b64 v[90:91], v[136:137]
    v_mov_b64 v[92:93], v[136:137]
    v_mov_b64 v[94:95], v[136:137]
    s_mov_b64 exec, s[74:75]
    buffer_load_dwordx4 v[88:91], v3, s[24:27], s11 offen offset:2048 sc1
    buffer_load_dwordx4 v[92:95], v3, s[24:27], s11 offen offset:2560 sc1
    s_mov_b64 exec, -1
    ds_read_b64_tr_b16 v[216:217], v151 offset:0
    ds_read_b64_tr_b16 v[218:219], v151 offset:768
    ds_read_b64_tr_b16 v[220:221], v151 offset:32
    ds_read_b64_tr_b16 v[222:223], v151 offset:800
    ds_read_b64_tr_b16 v[224:225], v151 offset:64
    ds_read_b64_tr_b16 v[226:227], v151 offset:832
    s_waitcnt lgkmcnt(6)
    v_mfma_f32_32x32x16_bf16 v[168:183], v[228:231], v[116:119], v[168:183]
    v_mfma_f32_32x32x16_bf16 v[184:199], v[232:235], v[116:119], v[184:199]
    v_mfma_f32_32x32x16_bf16 v[200:215], v[236:239], v[116:119], v[200:215]
    v_mov_b64 v[96:97], v[136:137]
    v_mov_b64 v[98:99], v[136:137]
    v_mov_b64 v[100:101], v[136:137]
    v_mov_b64 v[102:103], v[136:137]
    s_mov_b64 exec, s[74:75]
    buffer_load_dwordx4 v[96:99], v3, s[24:27], s11 offen offset:3072 sc1
    buffer_load_dwordx4 v[100:103], v3, s[24:27], s11 offen offset:3584 sc1
    s_mov_b64 exec, -1
    s_add_u32 s34, s7, 1
    s_and_b32 s34, s34, 7
    s_xor_b32 s34, s34, s39
    s_lshl_b32 s34, s34, 10
    s_add_u32 s34, s34, s6
    buffer_load_dwordx4 v[164:167], v2, s[24:27], s34 offen sc1
    ds_read_b64_tr_b16 v[228:229], v151 offset:3072
    ds_read_b64_tr_b16 v[230:231], v151 offset:3840
    ds_read_b64_tr_b16 v[232:233], v151 offset:3104
    ds_read_b64_tr_b16 v[234:235], v151 offset:3872
    ds_read_b64_tr_b16 v[236:237], v151 offset:3136
    ds_read_b64_tr_b16 v[238:239], v151 offset:3904
    s_waitcnt lgkmcnt(6)
    v_mfma_f32_32x32x16_bf16 v[168:183], v[216:219], v[120:123], v[168:183]
    v_mfma_f32_32x32x16_bf16 v[184:199], v[220:223], v[120:123], v[184:199]
    v_mfma_f32_32x32x16_bf16 v[200:215], v[224:227], v[120:123], v[200:215]
    ds_read_b64_tr_b16 v[216:217], v151 offset:6144
    ds_read_b64_tr_b16 v[218:219], v151 offset:6912
    ds_read_b64_tr_b16 v[220:221], v151 offset:6176
    ds_read_b64_tr_b16 v[222:223], v151 offset:6944
    ds_read_b64_tr_b16 v[224:225], v151 offset:6208
    ds_read_b64_tr_b16 v[226:227], v151 offset:6976
    s_waitcnt lgkmcnt(6)
    v_mfma_f32_32x32x16_bf16 v[168:183], v[228:231], v[124:127], v[168:183]
    v_mfma_f32_32x32x16_bf16 v[184:199], v[232:235], v[124:127], v[184:199]
    v_mfma_f32_32x32x16_bf16 v[200:215], v[236:239], v[124:127], v[200:215]
    ds_read_b64_tr_b16 v[228:229], v151 offset:9216
    ds_read_b64_tr_b16 v[230:231], v151 offset:9984
    ds_read_b64_tr_b16 v[232:233], v151 offset:9248
    ds_read_b64_tr_b16 v[234:235], v151 offset:10016
    ds_read_b64_tr_b16 v[236:237], v151 offset:9280
    ds_read_b64_tr_b16 v[238:239], v151 offset:10048
    s_waitcnt lgkmcnt(6)
    v_mfma_f32_32x32x16_bf16 v[168:183], v[216:219], v[128:131], v[168:183]
    v_mfma_f32_32x32x16_bf16 v[184:199], v[220:223], v[128:131], v[184:199]
    v_mfma_f32_32x32x16_bf16 v[200:215], v[224:227], v[128:131], v[200:215]
    s_waitcnt lgkmcnt(0)
    s_lshl_b32 s68, s3, 2
    s_add_u32 s68, s68, 155616
    v_mov_b32 v240, s68
    ds_write_b32 v240, v240
    v_mfma_f32_32x32x16_bf16 v[168:183], v[228:231], v[132:135], v[168:183]
    v_mfma_f32_32x32x16_bf16 v[184:199], v[232:235], v[132:135], v[184:199]
    v_mfma_f32_32x32x16_bf16 v[200:215], v[236:239], v[132:135], v[200:215]
    s_mov_b32 s72, 0xbdd2d3e8
    s_mov_b32 s73, s72
    v_mov_b32 v4, 0xc0135761
    s_mul_i32 s70, s69, 86
    s_mul_i32 s71, s13, 6
    s_add_u32 s71, s71, 0
    s_add_u32 s70, s70, s71
    s_lshl_b32 s70, s70, 10
    s_add_u32 s70, s70, 8388608
    s_lshl_b32 s68, s69, 12
    s_add_u32 s68, s68, 14024704
    s_setprio 3
    s_cmp_ge_u32 s71, 86
    s_cselect_b32 s70, s68, s70
    v_pk_mul_f32 v[240:241], v[168:169], v[168:169]
    v_pk_mul_f32 v[242:243], v[170:171], v[170:171]
    v_pk_mul_f32 v[244:245], v[172:173], v[172:173]
    v_pk_mul_f32 v[246:247], v[174:175], v[174:175]
    v_pk_fma_f32 v[240:241], v[240:241], s[72:73], v[4:5] op_sel_hi:[1,1,0]
    v_pk_fma_f32 v[242:243], v[242:243], s[72:73], v[4:5] op_sel_hi:[1,1,0]
    v_pk_fma_f32 v[244:245], v[244:245], s[72:73], v[4:5] op_sel_hi:[1,1,0]
    v_pk_fma_f32 v[246:247], v[246:247], s[72:73], v[4:5] op_sel_hi:[1,1,0]
    v_pk_mul_f32 v[240:241], v[240:241], v[168:169]
    v_pk_mul_f32 v[242:243], v[242:243], v[170:171]
    v_pk_mul_f32 v[244:245], v[244:245], v[172:173]
    v_pk_mul_f32 v[246:247], v[246:247], v[174:175]
    v_exp_f32 v240, v240
    v_exp_f32 v241, v241
    v_exp_f32 v242, v242
    v_exp_f32 v243, v243
    v_exp_f32 v244, v244
    v_exp_f32 v245, v245
    v_exp_f32 v246, v246
    v_exp_f32 v247, v247
    v_pk_fma_f32 v[240:241], v[240:241], v[0:1], v[0:1] op_sel_hi:[1,0,0]
    v_pk_fma_f32 v[242:243], v[242:243], v[0:1], v[0:1] op_sel_hi:[1,0,0]
    v_pk_fma_f32 v[244:245], v[244:245], v[0:1], v[0:1] op_sel_hi:[1,0,0]
    v_pk_fma_f32 v[246:247], v[246:247], v[0:1], v[0:1] op_sel_hi:[1,0,0]
    v_rcp_f32 v240, v240
    v_rcp_f32 v241, v241
    v_rcp_f32 v242, v242
    v_rcp_f32 v243, v243
    v_rcp_f32 v244, v244
    v_rcp_f32 v245, v245
    v_rcp_f32 v246, v246
    v_rcp_f32 v247, v247
    v_pk_mul_f32 v[240:241], v[240:241], v[168:169]
    v_pk_mul_f32 v[242:243], v[242:243], v[170:171]
    v_pk_mul_f32 v[244:245], v[244:245], v[172:173]
    v_pk_mul_f32 v[246:247], v[246:247], v[174:175]
    v_pk_mul_f32 v[240:241], v[240:241], v[176:177]
    v_pk_mul_f32 v[242:243], v[242:243], v[178:179]
    v_pk_mul_f32 v[244:245], v[244:245], v[180:181]
    v_pk_mul_f32 v[246:247], v[246:247], v[182:183]
    v_cvt_pk_bf16_f32 v168, v240, v241
    v_cvt_pk_bf16_f32 v169, v242, v243
    v_cvt_pk_bf16_f32 v170, v244, v245
    v_cvt_pk_bf16_f32 v171, v246, v247
    buffer_store_dwordx4 v[168:171], v2, s[24:27], s70 offen offset:0 sc1
    s_cmp_ge_u32 s71, 85
    s_cselect_b32 s70, s68, s70
    v_pk_mul_f32 v[248:249], v[184:185], v[184:185]
    v_pk_mul_f32 v[250:251], v[186:187], v[186:187]
    v_pk_mul_f32 v[252:253], v[188:189], v[188:189]
    v_pk_mul_f32 v[254:255], v[190:191], v[190:191]
    v_pk_fma_f32 v[248:249], v[248:249], s[72:73], v[4:5] op_sel_hi:[1,1,0]
    v_pk_fma_f32 v[250:251], v[250:251], s[72:73], v[4:5] op_sel_hi:[1,1,0]
    v_pk_fma_f32 v[252:253], v[252:253], s[72:73], v[4:5] op_sel_hi:[1,1,0]
    v_pk_fma_f32 v[254:255], v[254:255], s[72:73], v[4:5] op_sel_hi:[1,1,0]
    v_pk_mul_f32 v[248:249], v[248:249], v[184:185]
    v_pk_mul_f32 v[250:251], v[250:251], v[186:187]
    v_pk_mul_f32 v[252:253], v[252:253], v[188:189]
    v_pk_mul_f32 v[254:255], v[254:255], v[190:191]
    v_exp_f32 v248, v248
    v_exp_f32 v249, v249
    v_exp_f32 v250, v250
    v_exp_f32 v251, v251
    v_exp_f32 v252, v252
    v_exp_f32 v253, v253
    v_exp_f32 v254, v254
    v_exp_f32 v255, v255
    v_pk_fma_f32 v[248:249], v[248:249], v[0:1], v[0:1] op_sel_hi:[1,0,0]
    v_pk_fma_f32 v[250:251], v[250:251], v[0:1], v[0:1] op_sel_hi:[1,0,0]
    v_pk_fma_f32 v[252:253], v[252:253], v[0:1], v[0:1] op_sel_hi:[1,0,0]
    v_pk_fma_f32 v[254:255], v[254:255], v[0:1], v[0:1] op_sel_hi:[1,0,0]
    v_rcp_f32 v248, v248
    v_rcp_f32 v249, v249
    v_rcp_f32 v250, v250
    v_rcp_f32 v251, v251
    v_rcp_f32 v252, v252
    v_rcp_f32 v253, v253
    v_rcp_f32 v254, v254
    v_rcp_f32 v255, v255
    v_pk_mul_f32 v[248:249], v[248:249], v[184:185]
    v_pk_mul_f32 v[250:251], v[250:251], v[186:187]
    v_pk_mul_f32 v[252:253], v[252:253], v[188:189]
    v_pk_mul_f32 v[254:255], v[254:255], v[190:191]
    v_pk_mul_f32 v[248:249], v[248:249], v[192:193]
    v_pk_mul_f32 v[250:251], v[250:251], v[194:195]
    v_pk_mul_f32 v[252:253], v[252:253], v[196:197]
    v_pk_mul_f32 v[254:255], v[254:255], v[198:199]
    v_cvt_pk_bf16_f32 v184, v248, v249
    v_cvt_pk_bf16_f32 v185, v250, v251
    v_cvt_pk_bf16_f32 v186, v252, v253
    v_cvt_pk_bf16_f32 v187, v254, v255
    buffer_store_dwordx4 v[184:187], v2, s[24:27], s70 offen offset:1024 sc1
    s_cmp_ge_u32 s71, 84
    s_cselect_b32 s70, s68, s70
    v_pk_mul_f32 v[240:241], v[200:201], v[200:201]
    v_pk_mul_f32 v[242:243], v[202:203], v[202:203]
    v_pk_mul_f32 v[244:245], v[204:205], v[204:205]
    v_pk_mul_f32 v[246:247], v[206:207], v[206:207]
    v_pk_fma_f32 v[240:241], v[240:241], s[72:73], v[4:5] op_sel_hi:[1,1,0]
    v_pk_fma_f32 v[242:243], v[242:243], s[72:73], v[4:5] op_sel_hi:[1,1,0]
    v_pk_fma_f32 v[244:245], v[244:245], s[72:73], v[4:5] op_sel_hi:[1,1,0]
    v_pk_fma_f32 v[246:247], v[246:247], s[72:73], v[4:5] op_sel_hi:[1,1,0]
    v_pk_mul_f32 v[240:241], v[240:241], v[200:201]
    v_pk_mul_f32 v[242:243], v[242:243], v[202:203]
    v_pk_mul_f32 v[244:245], v[244:245], v[204:205]
    v_pk_mul_f32 v[246:247], v[246:247], v[206:207]
    v_exp_f32 v240, v240
    v_exp_f32 v241, v241
    v_exp_f32 v242, v242
    v_exp_f32 v243, v243
    v_exp_f32 v244, v244
    v_exp_f32 v245, v245
    v_exp_f32 v246, v246
    v_exp_f32 v247, v247
    v_pk_fma_f32 v[240:241], v[240:241], v[0:1], v[0:1] op_sel_hi:[1,0,0]
    v_pk_fma_f32 v[242:243], v[242:243], v[0:1], v[0:1] op_sel_hi:[1,0,0]
    v_pk_fma_f32 v[244:245], v[244:245], v[0:1], v[0:1] op_sel_hi:[1,0,0]
    v_pk_fma_f32 v[246:247], v[246:247], v[0:1], v[0:1] op_sel_hi:[1,0,0]
    v_rcp_f32 v240, v240
    v_rcp_f32 v241, v241
    v_rcp_f32 v242, v242
    v_rcp_f32 v243, v243
    v_rcp_f32 v244, v244
    v_rcp_f32 v245, v245
    v_rcp_f32 v246, v246
    v_rcp_f32 v247, v247
    v_pk_mul_f32 v[240:241], v[240:241], v[200:201]
    v_pk_mul_f32 v[242:243], v[242:243], v[202:203]
    v_pk_mul_f32 v[244:245], v[244:245], v[204:205]
    v_pk_mul_f32 v[246:247], v[246:247], v[206:207]
    v_pk_mul_f32 v[240:241], v[240:241], v[208:209]
    v_pk_mul_f32 v[242:243], v[242:243], v[210:211]
    v_pk_mul_f32 v[244:245], v[244:245], v[212:213]
    v_pk_mul_f32 v[246:247], v[246:247], v[214:215]
    v_cvt_pk_bf16_f32 v200, v240, v241
    v_cvt_pk_bf16_f32 v201, v242, v243
    v_cvt_pk_bf16_f32 v202, v244, v245
    v_cvt_pk_bf16_f32 v203, v246, v247
    buffer_store_dwordx4 v[200:203], v2, s[24:27], s70 offen offset:2048 sc1
    s_lshl_b32 s76, s39, 12
    s_add_u32 s76, s76, 122880
    s_add_u32 s77, s38, 0
    s_and_b32 s77, s77, 3
    s_lshl_b32 s77, s77, 10
    s_add_u32 s77, s77, s76
    v_add_u32 v4, s77, v2
    s_add_u32 s77, s38, 1
    s_and_b32 s77, s77, 3
    s_lshl_b32 s77, s77, 10
    s_add_u32 s77, s77, s76
    v_add_u32 v5, s77, v2
    s_add_u32 s77, s38, 2
    s_and_b32 s77, s77, 3
    s_lshl_b32 s77, s77, 10
    s_add_u32 s77, s77, s76
    v_add_u32 v0, s77, v2
    s_add_u32 s77, s38, 3
    s_and_b32 s77, s77, 3
    s_lshl_b32 s77, s77, 10
    s_add_u32 s77, s77, s76
    v_add_u32 v7, s77, v2
    s_setprio 0
    s_waitcnt vmcnt(27)
    v_mfma_f32_32x32x16_bf16 v[104:119], v[8:11], v[160:163], 0
    s_nop 7
    s_nop 3
    v_exp_f32 v104, v104
    v_exp_f32 v105, v105
    v_exp_f32 v106, v106
    v_cvt_pk_bf16_f32 v136, v104, v105
    v_exp_f32 v107, v107
    v_exp_f32 v108, v108
    v_cvt_pk_bf16_f32 v137, v106, v107
    v_exp_f32 v109, v109
    v_exp_f32 v110, v110
    s_waitcnt vmcnt(26)
    v_mfma_f32_32x32x16_bf16 v[120:135], v[12:15], v[160:163], 0
    v_cvt_pk_bf16_f32 v138, v108, v109
    v_exp_f32 v111, v111
    v_exp_f32 v112, v112
    v_cvt_pk_bf16_f32 v139, v110, v111
    v_exp_f32 v113, v113
    v_exp_f32 v114, v114
    v_exp_f32 v115, v115
    s_waitcnt vmcnt(24)
    v_mfma_f32_32x32x16_bf16 v[144:159], v[40:43], v[136:139], 0
    v_cvt_pk_bf16_f32 v140, v112, v113
    v_exp_f32 v116, v116
    v_cvt_pk_bf16_f32 v141, v114, v115
    v_exp_f32 v117, v117
    v_exp_f32 v118, v118
    v_cvt_pk_bf16_f32 v142, v116, v117
    v_exp_f32 v119, v119
    v_exp_f32 v120, v120
    s_setprio 2
    v_cvt_pk_bf16_f32 v143, v118, v119
    v_exp_f32 v121, v121
    v_exp_f32 v122, v122
    v_mfma_f32_32x32x16_bf16 v[144:159], v[44:47], v[140:143], v[144:159]
    v_cvt_pk_bf16_f32 v136, v120, v121
    v_exp_f32 v123, v123
    v_exp_f32 v124, v124
    v_cvt_pk_bf16_f32 v137, v122, v123
    v_exp_f32 v125, v125
    v_exp_f32 v126, v126
    s_waitcnt vmcnt(23)
    v_mfma_f32_32x32x16_bf16 v[104:119], v[16:19], v[160:163], 0
    v_cvt_pk_bf16_f32 v138, v124, v125
    v_exp_f32 v127, v127
    v_exp_f32 v128, v128
    v_cvt_pk_bf16_f32 v139, v126, v127
    v_exp_f32 v129, v129
    v_exp_f32 v130, v130
    v_exp_f32 v131, v131
    s_waitcnt vmcnt(21)
    v_mfma_f32_32x32x16_bf16 v[144:159], v[48:51], v[136:139], v[144:159]
    v_cvt_pk_bf16_f32 v140, v128, v129
    v_exp_f32 v132, v132
    v_cvt_pk_bf16_f32 v141, v130, v131
    v_exp_f32 v133, v133
    v_exp_f32 v134, v134
    v_cvt_pk_bf16_f32 v142, v132, v133
    v_exp_f32 v135, v135
    v_exp_f32 v104, v104
    v_cvt_pk_bf16_f32 v143, v134, v135
    v_exp_f32 v105, v105
    v_exp_f32 v106, v106
    v_mfma_f32_32x32x16_bf16 v[144:159], v[52:55], v[140:143], v[144:159]
    v_cvt_pk_bf16_f32 v136, v104, v105
    v_exp_f32 v107, v107
    v_exp_f32 v108, v108
    v_cvt_pk_bf16_f32 v137, v106, v107
    v_exp_f32 v109, v109
    v_exp_f32 v110, v110
    s_waitcnt vmcnt(20)
    v_mfma_f32_32x32x16_bf16 v[120:135], v[20:23], v[160:163], 0
    v_cvt_pk_bf16_f32 v138, v108, v109
    v_exp_f32 v111, v111
    v_exp_f32 v112, v112
    v_cvt_pk_bf16_f32 v139, v110, v111
    v_exp_f32 v113, v113
    v_exp_f32 v114, v114
    v_exp_f32 v115, v115
    s_waitcnt vmcnt(18)
    v_mfma_f32_32x32x16_bf16 v[144:159], v[56:59], v[136:139], v[144:159]
    v_cvt_pk_bf16_f32 v140, v112, v113
    v_exp_f32 v116, v116
    v_cvt_pk_bf16_f32 v141, v114, v115
    v_exp_f32 v117, v117
    v_exp_f32 v118, v118
    v_cvt_pk_bf16_f32 v142, v116, v117
    v_exp_f32 v119, v119
    v_exp_f32 v120, v120
    v_cvt_pk_bf16_f32 v143, v118, v119
    v_exp_f32 v121, v121
    v_exp_f32 v122, v122
    v_mfma_f32_32x32x16_bf16 v[144:159], v[60:63], v[140:143], v[144:159]
    v_cvt_pk_bf16_f32 v136, v120, v121
    v_exp_f32 v123, v123
    v_exp_f32 v124, v124
    v_cvt_pk_bf16_f32 v137, v122, v123
    v_exp_f32 v125, v125
    v_exp_f32 v126, v126
    s_waitcnt vmcnt(17)
    v_mfma_f32_32x32x16_bf16 v[104:119], v[24:27], v[160:163], 0
    v_cvt_pk_bf16_f32 v138, v124, v125
    v_exp_f32 v127, v127
    v_exp_f32 v128, v128
    v_cvt_pk_bf16_f32 v139, v126, v127
    v_exp_f32 v129, v129
    v_exp_f32 v130, v130
    v_exp_f32 v131, v131
    s_waitcnt vmcnt(15)
    v_mfma_f32_32x32x16_bf16 v[144:159], v[64:67], v[136:139], v[144:159]
    v_cvt_pk_bf16_f32 v140, v128, v129
    v_exp_f32 v132, v132
    v_cvt_pk_bf16_f32 v141, v130, v131
    v_exp_f32 v133, v133
    v_exp_f32 v134, v134
    v_cvt_pk_bf16_f32 v142, v132, v133
    v_exp_f32 v135, v135
    v_exp_f32 v104, v104
    v_cvt_pk_bf16_f32 v143, v134, v135
    v_exp_f32 v105, v105
    v_exp_f32 v106, v106
    v_mfma_f32_32x32x16_bf16 v[144:159], v[68:71], v[140:143], v[144:159]
    v_cvt_pk_bf16_f32 v136, v104, v105
    v_exp_f32 v107, v107
    v_exp_f32 v108, v108
    v_cvt_pk_bf16_f32 v137, v106, v107
    v_exp_f32 v109, v109
    v_exp_f32 v110, v110
    s_waitcnt vmcnt(14)
    v_mfma_f32_32x32x16_bf16 v[120:135], v[28:31], v[160:163], 0
    v_cvt_pk_bf16_f32 v138, v108, v109
    v_exp_f32 v111, v111
    v_exp_f32 v112, v112
    v_cvt_pk_bf16_f32 v139, v110, v111
    v_exp_f32 v113, v113
    v_exp_f32 v114, v114
    v_exp_f32 v115, v115
    s_waitcnt vmcnt(12)
    v_mfma_f32_32x32x16_bf16 v[144:159], v[72:75], v[136:139], v[144:159]
    v_cvt_pk_bf16_f32 v140, v112, v113
    v_exp_f32 v116, v116
    v_cvt_pk_bf16_f32 v141, v114, v115
    v_exp_f32 v117, v117
    v_exp_f32 v118, v118
    v_cvt_pk_bf16_f32 v142, v116, v117
    v_exp_f32 v119, v119
    v_exp_f32 v120, v120
    v_cvt_pk_bf16_f32 v143, v118, v119
    v_exp_f32 v121, v121
    v_exp_f32 v122, v122
    v_mfma_f32_32x32x16_bf16 v[144:159], v[76:79], v[140:143], v[144:159]
    v_cvt_pk_bf16_f32 v136, v120, v121
    v_exp_f32 v123, v123
    v_exp_f32 v124, v124
    v_cvt_pk_bf16_f32 v137, v122, v123
    v_exp_f32 v125, v125
    v_exp_f32 v126, v126
    s_waitcnt vmcnt(11)
    v_mfma_f32_32x32x16_bf16 v[104:119], v[32:35], v[160:163], 0
    v_cvt_pk_bf16_f32 v138, v124, v125
    v_exp_f32 v127, v127
    v_exp_f32 v128, v128
    v_cvt_pk_bf16_f32 v139, v126, v127
    v_exp_f32 v129, v129
    v_exp_f32 v130, v130
    v_exp_f32 v131, v131
    s_waitcnt vmcnt(9)
    v_mfma_f32_32x32x16_bf16 v[144:159], v[80:83], v[136:139], v[144:159]
    v_cvt_pk_bf16_f32 v140, v128, v129
    v_exp_f32 v132, v132
    v_cvt_pk_bf16_f32 v141, v130, v131
    v_exp_f32 v133, v133
    v_exp_f32 v134, v134
    v_cvt_pk_bf16_f32 v142, v132, v133
    v_exp_f32 v135, v135
    v_exp_f32 v104, v104
    v_cvt_pk_bf16_f32 v143, v134, v135
    v_exp_f32 v105, v105
    v_exp_f32 v106, v106
    v_mfma_f32_32x32x16_bf16 v[144:159], v[84:87], v[140:143], v[144:159]
    v_cvt_pk_bf16_f32 v136, v104, v105
    v_exp_f32 v107, v107
    v_exp_f32 v108, v108
    v_cvt_pk_bf16_f32 v137, v106, v107
    v_exp_f32 v109, v109
    v_exp_f32 v110, v110
    s_waitcnt vmcnt(8)
    v_mfma_f32_32x32x16_bf16 v[120:135], v[36:39], v[160:163], 0
    v_cvt_pk_bf16_f32 v138, v108, v109
    v_exp_f32 v111, v111
    v_exp_f32 v112, v112
    v_cvt_pk_bf16_f32 v139, v110, v111
    v_exp_f32 v113, v113
    v_exp_f32 v114, v114
    v_exp_f32 v115, v115
    s_waitcnt vmcnt(6)
    v_mfma_f32_32x32x16_bf16 v[144:159], v[88:91], v[136:139], v[144:159]
    v_cvt_pk_bf16_f32 v140, v112, v113
    v_exp_f32 v116, v116
    v_cvt_pk_bf16_f32 v141, v114, v115
    v_exp_f32 v117, v117
    v_exp_f32 v118, v118
    v_cvt_pk_bf16_f32 v142, v116, v117
    v_exp_f32 v119, v119
    v_exp_f32 v120, v120
    v_cvt_pk_bf16_f32 v143, v118, v119
    v_exp_f32 v121, v121
    v_exp_f32 v122, v122
    v_mfma_f32_32x32x16_bf16 v[144:159], v[92:95], v[140:143], v[144:159]
    v_cvt_pk_bf16_f32 v136, v120, v121
    v_exp_f32 v123, v123
    v_exp_f32 v124, v124
    v_cvt_pk_bf16_f32 v137, v122, v123
    v_exp_f32 v125, v125
    v_exp_f32 v126, v126
    v_cvt_pk_bf16_f32 v138, v124, v125
    v_and_b32 v253, 0x70, v2
    v_lshrrev_b32 v253, 2, v253
    v_add_u32 v253, 155616, v253
    ds_read_b32 v252, v253
    v_exp_f32 v127, v127
    v_exp_f32 v128, v128
    v_cvt_pk_bf16_f32 v139, v126, v127
    v_exp_f32 v129, v129
    v_exp_f32 v130, v130
    v_exp_f32 v131, v131
    s_waitcnt vmcnt(4)
    v_mfma_f32_32x32x16_bf16 v[144:159], v[96:99], v[136:139], v[144:159]
    v_cvt_pk_bf16_f32 v140, v128, v129
    v_exp_f32 v132, v132
    v_cvt_pk_bf16_f32 v141, v130, v131
    v_exp_f32 v133, v133
    v_exp_f32 v134, v134
    v_cvt_pk_bf16_f32 v142, v132, v133
    v_exp_f32 v135, v135
    s_branch join_2
p12_h1_4:
    s_mov_b32 s62, 43691
    v_add_u32 v2, 0, v1
    v_mul_lo_u32 v3, v2, s62
    v_lshrrev_b32 v240, 19, v3
    v_mul_u32_u24 v3, 12, v240
    v_sub_u32 v243, v2, v3
    v_add_u32 v2, 64, v1
    v_mul_lo_u32 v3, v2, s62
    v_lshrrev_b32 v241, 19, v3
    v_mul_u32_u24 v3, 12, v241
    v_sub_u32 v244, v2, v3
    v_add_u32 v2, 128, v1
    v_mul_lo_u32 v3, v2, s62
    v_lshrrev_b32 v242, 19, v3
    v_mul_u32_u24 v3, 12, v242
    v_sub_u32 v245, v2, v3
    s_mul_i32 s63, s15, 3072
    s_mov_b32 s20, s10
    s_mov_b32 s21, s11
    s_mov_b32 s22, 1409024
    s_mov_b32 s23, 0x20000
    s_mov_b32 s24, s60
    s_mov_b32 s25, s61
    s_mov_b32 s26, 15728640
    s_mov_b32 s27, 0x20000
    v_and_b32 v5, 31, v1
    v_lshrrev_b32 v6, 5, v1
    v_lshrrev_b32 v7, 1, v5
    v_and_b32 v7, 7, v7
    v_xor_b32 v7, v7, v6
    v_lshlrev_b32 v7, 4, v7
    v_lshl_add_u32 v7, v5, 7, v7
    s_lshl_b32 s68, s15, 12
    v_add_u32 v136, s68, v7
    v_xor_b32 v137, 32, v136
    v_xor_b32 v138, 64, v136
    v_xor_b32 v139, 96, v136
    v_add_u32 v140, 57344, v136
    v_add_u32 v141, 57344, v137
    v_add_u32 v142, 57344, v138
    v_add_u32 v143, 57344, v139
    v_add_u32 v144, 114688, v136
    v_add_u32 v145, 114688, v137
    v_add_u32 v146, 114688, v138
    v_add_u32 v147, 114688, v139
    v_bfe_u32 v2, v1, 2, 2
    v_lshl_add_u32 v2, v6, 3, v2
    v_mul_u32_u24 v2, 192, v2
    v_and_b32 v3, 3, v1
    v_lshl_add_u32 v2, v3, 3, v2
    v_bfe_u32 v3, v1, 4, 1
    v_lshl_add_u32 v148, v3, 5, v2
    v_add_u32 v148, 16512, v148
    v_mul_u32_u24 v3, 12320, v3
    v_add_u32 v151, v2, v3
    v_add_u32 v151, 96, v151
    v_add_u32 v149, 57344, v148
    v_add_u32 v152, 57344, v151
    v_add_u32 v150, 114688, v148
    v_add_u32 v153, 114688, v151
    v_mul_u32_u24 v2, 2752, v240
    v_lshl_add_u32 v157, v243, 4, v2
    v_mul_u32_u24 v2, 2752, v241
    v_lshl_add_u32 v158, v244, 4, v2
    v_mul_u32_u24 v2, 2752, v242
    v_lshl_add_u32 v159, v245, 4, v2
    s_mul_i32 s65, s15, 44032
    s_mul_i32 s68, s13, 192
    s_add_u32 s65, s65, s68
    v_lshlrev_b32 v7, 4, v6
    v_add_u32 v7, 143360, v7
    v_lshlrev_b32 v2, 4, v1
    s_mov_b32 s100, 14778368
    s_buffer_load_dword s100, s[24:27], s100
    s_mov_b32 s42, 1409024
    s_mov_b32 s43, 0x20000
    s_mov_b32 s46, 524288
    s_mov_b32 s47, 0x20000
    s_mov_b32 s50, 2097152
    s_mov_b32 s51, 0x20000
    s_lshl_b32 s68, s3, 10
    s_add_u32 s68, s68, 155648
    v_add_u32 v160, s68, v2
    v_mov_b64 v[164:165], 0
    v_mov_b64 v[166:167], 0
    ds_write_b128 v160, v[164:167]
    s_lshl_b32 s68, s3, 2
    s_add_u32 s68, s68, 155616
    v_mov_b32 v161, s68
    v_mov_b32 v162, -1
    ds_write_b32 v161, v162
    s_add_u32 s67, s14, 1
    s_and_b32 s67, s67, 7
    s_lshl_b32 s67, s67, 7
    s_add_u32 s67, s67, s64
    s_add_u32 m0, s66, 28672
    s_nop 0
    buffer_load_dwordx4 v154, s[16:19], s67 offen lds
    s_add_u32 m0, s66, 29696
    s_add_u32 s67, s67, 8192
    buffer_load_dwordx4 v155, s[16:19], s67 offen lds
    s_add_u32 m0, s66, 30720
    s_add_u32 s67, s67, 8192
    buffer_load_dwordx4 v154, s[16:19], s67 offen lds
    s_add_u32 m0, s66, 31744
    s_add_u32 s67, s67, 8192
    buffer_load_dwordx4 v155, s[16:19], s67 offen lds
    s_add_u32 s67, s14, 2
    s_and_b32 s67, s67, 7
    s_lshl_b32 s67, s67, 7
    s_add_u32 s67, s67, s64
    s_add_u32 m0, s66, 57344
    s_nop 0
    buffer_load_dwordx4 v154, s[16:19], s67 offen lds
    s_add_u32 m0, s66, 58368
    s_add_u32 s67, s67, 8192
    buffer_load_dwordx4 v155, s[16:19], s67 offen lds
    s_add_u32 m0, s66, 59392
    s_add_u32 s67, s67, 8192
    buffer_load_dwordx4 v154, s[16:19], s67 offen lds
    s_add_u32 m0, s66, 60416
    s_add_u32 s67, s67, 8192
    buffer_load_dwordx4 v155, s[16:19], s67 offen lds
    s_waitcnt vmcnt(8)
    s_barrier
    ds_read_b128 v[8:11], v136 offset:0
    ds_read_b64_tr_b16 v[216:217], v148 offset:0
    ds_read_b64_tr_b16 v[218:219], v148 offset:768
    ds_read_b128 v[220:223], v7 offset:0
    ds_read_b128 v[12:15], v137 offset:0
    ds_read_b64_tr_b16 v[228:229], v148 offset:3072
    ds_read_b64_tr_b16 v[230:231], v148 offset:3840
    ds_read_b128 v[232:235], v7 offset:32
    s_waitcnt lgkmcnt(4)
    v_mfma_f32_32x32x16_bf16 v[168:183], v[8:11], v[216:219], 0
    v_mfma_f32_32x32x16_bf16 v[184:199], v[220:223], v[8:11], 0
    s_add_u32 s67, s14, 3
    s_and_b32 s67, s67, 7
    s_lshl_b32 s67, s67, 7
    s_add_u32 s67, s67, s64
    s_add_u32 m0, s66, 86016
    s_nop 0
    buffer_load_dwordx4 v154, s[16:19], s67 offen lds
    ds_read_b128 v[16:19], v138 offset:0
    ds_read_b64_tr_b16 v[216:217], v148 offset:6144
    ds_read_b64_tr_b16 v[218:219], v148 offset:6912
    ds_read_b128 v[220:223], v7 offset:64
    s_waitcnt lgkmcnt(4)
    v_mfma_f32_32x32x16_bf16 v[168:183], v[12:15], v[228:231], v[168:183]
    v_mfma_f32_32x32x16_bf16 v[184:199], v[232:235], v[12:15], v[184:199]
    s_add_u32 m0, s66, 87040
    s_add_u32 s67, s67, 8192
    buffer_load_dwordx4 v155, s[16:19], s67 offen lds
    ds_read_b128 v[20:23], v139 offset:0
    ds_read_b64_tr_b16 v[228:229], v148 offset:9216
    ds_read_b64_tr_b16 v[230:231], v148 offset:9984
    ds_read_b128 v[232:235], v7 offset:96
    s_waitcnt lgkmcnt(4)
    v_mfma_f32_32x32x16_bf16 v[168:183], v[16:19], v[216:219], v[168:183]
    v_mfma_f32_32x32x16_bf16 v[184:199], v[220:223], v[16:19], v[184:199]
    s_add_u32 m0, s66, 88064
    s_add_u32 s67, s67, 8192
    buffer_load_dwordx4 v154, s[16:19], s67 offen lds
    s_waitcnt vmcnt(7) lgkmcnt(0)
    s_barrier
    ds_read_b128 v[24:27], v136 offset:28672
    ds_read_b64_tr_b16 v[216:217], v148 offset:28672
    ds_read_b64_tr_b16 v[218:219], v148 offset:29440
    ds_read_b128 v[220:223], v7 offset:128
    v_mfma_f32_32x32x16_bf16 v[168:183], v[20:23], v[228:231], v[168:183]
    v_mfma_f32_32x32x16_bf16 v[184:199], v[232:235], v[20:23], v[184:199]
    s_add_u32 m0, s66, 89088
    s_add_u32 s67, s67, 8192
    buffer_load_dwordx4 v155, s[16:19], s67 offen lds
    ds_read_b128 v[28:31], v137 offset:28672
    ds_read_b64_tr_b16 v[228:229], v148 offset:31744
    ds_read_b64_tr_b16 v[230:231], v148 offset:32512
    ds_read_b128 v[232:235], v7 offset:160
    s_waitcnt lgkmcnt(4)
    v_mfma_f32_32x32x16_bf16 v[168:183], v[24:27], v[216:219], v[168:183]
    v_mfma_f32_32x32x16_bf16 v[184:199], v[220:223], v[24:27], v[184:199]
    s_add_u32 s67, s14, 4
    s_and_b32 s67, s67, 7
    s_lshl_b32 s67, s67, 7
    s_add_u32 s67, s67, s64
    s_add_u32 m0, s66, 114688
    s_nop 0
    buffer_load_dwordx4 v154, s[16:19], s67 offen lds
    s_add_u32 s100, s100, 0x9E3779B9
    ds_read_b128 v[32:35], v138 offset:28672
    ds_read_b64_tr_b16 v[216:217], v148 offset:34816
    ds_read_b64_tr_b16 v[218:219], v148 offset:35584
    ds_read_b128 v[220:223], v7 offset:192
    s_waitcnt lgkmcnt(4)
    v_mfma_f32_32x32x16_bf16 v[168:183], v[28:31], v[228:231], v[168:183]
    v_mfma_f32_32x32x16_bf16 v[184:199], v[232:235], v[28:31], v[184:199]
    s_add_u32 m0, s66, 115712
    s_add_u32 s67, s67, 8192
    buffer_load_dwordx4 v155, s[16:19], s67 offen lds
    ds_read_b128 v[36:39], v139 offset:28672
    ds_read_b64_tr_b16 v[228:229], v148 offset:37888
    ds_read_b64_tr_b16 v[230:231], v148 offset:38656
    ds_read_b128 v[232:235], v7 offset:224
    s_waitcnt lgkmcnt(4)
    v_mfma_f32_32x32x16_bf16 v[168:183], v[32:35], v[216:219], v[168:183]
    v_mfma_f32_32x32x16_bf16 v[184:199], v[220:223], v[32:35], v[184:199]
    s_add_u32 m0, s66, 116736
    s_add_u32 s67, s67, 8192
    buffer_load_dwordx4 v154, s[16:19], s67 offen lds
    s_waitcnt vmcnt(7) lgkmcnt(0)
    s_barrier
    ds_read_b128 v[40:43], v140 offset:0
    ds_read_b64_tr_b16 v[216:217], v149 offset:0
    ds_read_b64_tr_b16 v[218:219], v149 offset:768
    ds_read_b128 v[220:223], v7 offset:256
    v_mfma_f32_32x32x16_bf16 v[168:183], v[36:39], v[228:231], v[168:183]
    v_mfma_f32_32x32x16_bf16 v[184:199], v[232:235], v[36:39], v[184:199]
    s_add_u32 m0, s66, 117760
    s_add_u32 s67, s67, 8192
    buffer_load_dwordx4 v155, s[16:19], s67 offen lds
    ds_read_b128 v[44:47], v141 offset:0
    ds_read_b64_tr_b16 v[228:229], v149 offset:3072
    ds_read_b64_tr_b16 v[230:231], v149 offset:3840
    ds_read_b128 v[232:235], v7 offset:288
    s_waitcnt lgkmcnt(4)
    v_mfma_f32_32x32x16_bf16 v[168:183], v[40:43], v[216:219], v[168:183]
    v_mfma_f32_32x32x16_bf16 v[184:199], v[220:223], v[40:43], v[184:199]
    s_add_u32 s67, s14, 5
    s_and_b32 s67, s67, 7
    s_lshl_b32 s67, s67, 7
    s_add_u32 s67, s67, s64
    s_add_u32 m0, s66, 0
    s_nop 0
    buffer_load_dwordx4 v154, s[16:19], s67 offen lds
    ds_read_b128 v[48:51], v142 offset:0
    ds_read_b64_tr_b16 v[216:217], v149 offset:6144
    ds_read_b64_tr_b16 v[218:219], v149 offset:6912
    ds_read_b128 v[220:223], v7 offset:320
    s_waitcnt lgkmcnt(4)
    v_mfma_f32_32x32x16_bf16 v[168:183], v[44:47], v[228:231], v[168:183]
    v_mfma_f32_32x32x16_bf16 v[184:199], v[232:235], v[44:47], v[184:199]
    s_add_u32 m0, s66, 1024
    s_add_u32 s67, s67, 8192
    buffer_load_dwordx4 v155, s[16:19], s67 offen lds
    ds_read_b128 v[52:55], v143 offset:0
    ds_read_b64_tr_b16 v[228:229], v149 offset:9216
    ds_read_b64_tr_b16 v[230:231], v149 offset:9984
    ds_read_b128 v[232:235], v7 offset:352
    s_waitcnt lgkmcnt(4)
    v_mfma_f32_32x32x16_bf16 v[168:183], v[48:51], v[216:219], v[168:183]
    v_mfma_f32_32x32x16_bf16 v[184:199], v[220:223], v[48:51], v[184:199]
    s_add_u32 m0, s66, 2048
    s_add_u32 s67, s67, 8192
    buffer_load_dwordx4 v154, s[16:19], s67 offen lds
    s_waitcnt vmcnt(7) lgkmcnt(0)
    s_barrier
    ds_read_b128 v[56:59], v140 offset:28672
    ds_read_b64_tr_b16 v[216:217], v149 offset:28672
    ds_read_b64_tr_b16 v[218:219], v149 offset:29440
    ds_read_b128 v[220:223], v7 offset:384
    v_mfma_f32_32x32x16_bf16 v[168:183], v[52:55], v[228:231], v[168:183]
    v_mfma_f32_32x32x16_bf16 v[184:199], v[232:235], v[52:55], v[184:199]
    s_add_u32 m0, s66, 3072
    s_add_u32 s67, s67, 8192
    buffer_load_dwordx4 v155, s[16:19], s67 offen lds
    ds_read_b128 v[60:63], v141 offset:28672
    ds_read_b64_tr_b16 v[228:229], v149 offset:31744
    ds_read_b64_tr_b16 v[230:231], v149 offset:32512
    ds_read_b128 v[232:235], v7 offset:416
    s_waitcnt lgkmcnt(4)
    v_mfma_f32_32x32x16_bf16 v[168:183], v[56:59], v[216:219], v[168:183]
    v_mfma_f32_32x32x16_bf16 v[184:199], v[220:223], v[56:59], v[184:199]
    s_add_u32 s67, s14, 6
    s_and_b32 s67, s67, 7
    s_lshl_b32 s67, s67, 7
    s_add_u32 s67, s67, s64
    s_add_u32 m0, s66, 28672
    s_nop 0
    buffer_load_dwordx4 v154, s[16:19], s67 offen lds
    s_add_u32 m0, s66, 29696
    s_add_u32 s67, s67, 8192
    buffer_load_dwordx4 v155, s[16:19], s67 offen lds
    ds_read_b128 v[64:67], v142 offset:28672
    ds_read_b64_tr_b16 v[216:217], v149 offset:34816
    ds_read_b64_tr_b16 v[218:219], v149 offset:35584
    ds_read_b128 v[220:223], v7 offset:448
    s_waitcnt lgkmcnt(4)
    v_mfma_f32_32x32x16_bf16 v[168:183], v[60:63], v[228:231], v[168:183]
    v_mfma_f32_32x32x16_bf16 v[184:199], v[232:235], v[60:63], v[184:199]
    s_add_u32 m0, s66, 30720
    s_add_u32 s67, s67, 8192
    buffer_load_dwordx4 v154, s[16:19], s67 offen lds
    ds_read_b128 v[68:71], v143 offset:28672
    ds_read_b64_tr_b16 v[228:229], v149 offset:37888
    ds_read_b64_tr_b16 v[230:231], v149 offset:38656
    ds_read_b128 v[232:235], v7 offset:480
    s_waitcnt lgkmcnt(4)
    v_mfma_f32_32x32x16_bf16 v[168:183], v[64:67], v[216:219], v[168:183]
    v_mfma_f32_32x32x16_bf16 v[184:199], v[220:223], v[64:67], v[184:199]
    s_add_u32 m0, s66, 31744
    s_add_u32 s67, s67, 8192
    buffer_load_dwordx4 v155, s[16:19], s67 offen lds
    s_waitcnt vmcnt(8) lgkmcnt(0)
    s_barrier
    ds_read_b128 v[72:75], v144 offset:0
    ds_read_b64_tr_b16 v[216:217], v150 offset:0
    ds_read_b64_tr_b16 v[218:219], v150 offset:768
    ds_read_b128 v[220:223], v7 offset:512
    v_mfma_f32_32x32x16_bf16 v[168:183], v[68:71], v[228:231], v[168:183]
    v_mfma_f32_32x32x16_bf16 v[184:199], v[232:235], v[68:71], v[184:199]
    s_add_u32 s67, s14, 7
    s_and_b32 s67, s67, 7
    s_lshl_b32 s67, s67, 7
    s_add_u32 s67, s67, s64
    s_add_u32 m0, s66, 57344
    s_nop 0
    buffer_load_dwordx4 v154, s[16:19], s67 offen lds
    ds_read_b128 v[76:79], v145 offset:0
    ds_read_b64_tr_b16 v[228:229], v150 offset:3072
    ds_read_b64_tr_b16 v[230:231], v150 offset:3840
    ds_read_b128 v[232:235], v7 offset:544
    s_waitcnt lgkmcnt(4)
    v_mfma_f32_32x32x16_bf16 v[168:183], v[72:75], v[216:219], v[168:183]
    v_mfma_f32_32x32x16_bf16 v[184:199], v[220:223], v[72:75], v[184:199]
    s_add_u32 m0, s66, 58368
    s_add_u32 s67, s67, 8192
    buffer_load_dwordx4 v155, s[16:19], s67 offen lds
    ds_read_b128 v[80:83], v146 offset:0
    ds_read_b64_tr_b16 v[216:217], v150 offset:6144
    ds_read_b64_tr_b16 v[218:219], v150 offset:6912
    ds_read_b128 v[220:223], v7 offset:576
    s_waitcnt lgkmcnt(4)
    v_mfma_f32_32x32x16_bf16 v[168:183], v[76:79], v[228:231], v[168:183]
    v_mfma_f32_32x32x16_bf16 v[184:199], v[232:235], v[76:79], v[184:199]
    s_add_u32 m0, s66, 59392
    s_add_u32 s67, s67, 8192
    buffer_load_dwordx4 v154, s[16:19], s67 offen lds
    s_add_u32 m0, s66, 60416
    s_add_u32 s67, s67, 8192
    buffer_load_dwordx4 v155, s[16:19], s67 offen lds
    ds_read_b128 v[84:87], v147 offset:0
    ds_read_b64_tr_b16 v[228:229], v150 offset:9216
    ds_read_b64_tr_b16 v[230:231], v150 offset:9984
    ds_read_b128 v[232:235], v7 offset:608
    s_waitcnt lgkmcnt(4)
    v_mfma_f32_32x32x16_bf16 v[168:183], v[80:83], v[216:219], v[168:183]
    v_mfma_f32_32x32x16_bf16 v[184:199], v[220:223], v[80:83], v[184:199]
    s_add_u32 s67, s14, 8
    s_and_b32 s67, s67, 7
    s_mul_i32 s67, s67, 176128
    s_add_u32 s67, s67, s65
    s_add_u32 m0, s63, 98336
    s_nop 0
    buffer_load_dwordx4 v157, s[20:23], s67 offen lds
    s_waitcnt vmcnt(9) lgkmcnt(0)
    s_barrier
    ds_read_b128 v[88:91], v136 offset:0
    ds_read_b64_tr_b16 v[216:217], v148 offset:0
    ds_read_b64_tr_b16 v[218:219], v148 offset:768
    ds_read_b128 v[220:223], v7 offset:640
    v_mfma_f32_32x32x16_bf16 v[168:183], v[84:87], v[228:231], v[168:183]
    v_mfma_f32_32x32x16_bf16 v[184:199], v[232:235], v[84:87], v[184:199]
    s_add_u32 m0, s63, 99360
    s_nop 0
    buffer_load_dwordx4 v158, s[20:23], s67 offen lds
    s_add_u32 m0, s63, 100384
    s_nop 0
    buffer_load_dwordx4 v159, s[20:23], s67 offen lds
    ds_read_b128 v[92:95], v137 offset:0
    ds_read_b64_tr_b16 v[228:229], v148 offset:3072
    ds_read_b64_tr_b16 v[230:231], v148 offset:3840
    ds_read_b128 v[232:235], v7 offset:672
    s_waitcnt lgkmcnt(4)
    v_mfma_f32_32x32x16_bf16 v[168:183], v[88:91], v[216:219], v[168:183]
    v_mfma_f32_32x32x16_bf16 v[184:199], v[220:223], v[88:91], v[184:199]
    ds_read_b128 v[96:99], v138 offset:0
    ds_read_b64_tr_b16 v[216:217], v148 offset:6144
    ds_read_b64_tr_b16 v[218:219], v148 offset:6912
    ds_read_b128 v[220:223], v7 offset:704
    s_waitcnt lgkmcnt(4)
    v_mfma_f32_32x32x16_bf16 v[168:183], v[92:95], v[228:231], v[168:183]
    v_mfma_f32_32x32x16_bf16 v[184:199], v[232:235], v[92:95], v[184:199]
    ds_read_b128 v[100:103], v139 offset:0
    ds_read_b64_tr_b16 v[228:229], v148 offset:9216
    ds_read_b64_tr_b16 v[230:231], v148 offset:9984
    ds_read_b128 v[232:235], v7 offset:736
    s_waitcnt lgkmcnt(4)
    v_mfma_f32_32x32x16_bf16 v[168:183], v[96:99], v[216:219], v[168:183]
    v_mfma_f32_32x32x16_bf16 v[184:199], v[220:223], v[96:99], v[184:199]
    s_waitcnt vmcnt(7) lgkmcnt(0)
    s_barrier
    ds_read_b128 v[104:107], v136 offset:28672
    ds_read_b64_tr_b16 v[216:217], v148 offset:28672
    ds_read_b64_tr_b16 v[218:219], v148 offset:29440
    ds_read_b128 v[220:223], v7 offset:768
    v_mfma_f32_32x32x16_bf16 v[168:183], v[100:103], v[228:231], v[168:183]
    v_mfma_f32_32x32x16_bf16 v[184:199], v[232:235], v[100:103], v[184:199]
    ds_read_b128 v[108:111], v137 offset:28672
    ds_read_b64_tr_b16 v[228:229], v148 offset:31744
    ds_read_b64_tr_b16 v[230:231], v148 offset:32512
    ds_read_b128 v[232:235], v7 offset:800
    s_waitcnt lgkmcnt(4)
    v_mfma_f32_32x32x16_bf16 v[168:183], v[104:107], v[216:219], v[168:183]
    v_mfma_f32_32x32x16_bf16 v[184:199], v[220:223], v[104:107], v[184:199]
    ds_read_b128 v[112:115], v138 offset:28672
    ds_read_b64_tr_b16 v[216:217], v148 offset:34816
    ds_read_b64_tr_b16 v[218:219], v148 offset:35584
    ds_read_b128 v[220:223], v7 offset:832
    s_waitcnt lgkmcnt(4)
    v_mfma_f32_32x32x16_bf16 v[168:183], v[108:111], v[228:231], v[168:183]
    v_mfma_f32_32x32x16_bf16 v[184:199], v[232:235], v[108:111], v[184:199]
    ds_read_b128 v[116:119], v139 offset:28672
    ds_read_b64_tr_b16 v[228:229], v148 offset:37888
    ds_read_b64_tr_b16 v[230:231], v148 offset:38656
    ds_read_b128 v[232:235], v7 offset:864
    s_waitcnt lgkmcnt(4)
    v_mfma_f32_32x32x16_bf16 v[168:183], v[112:115], v[216:219], v[168:183]
    v_mfma_f32_32x32x16_bf16 v[184:199], v[220:223], v[112:115], v[184:199]
    s_add_u32 s67, s14, 9
    s_and_b32 s67, s67, 7
    s_mul_i32 s67, s67, 176128
    s_add_u32 s67, s67, s65
    s_add_u32 m0, s63, 127008
    s_nop 0
    buffer_load_dwordx4 v157, s[20:23], s67 offen lds
    s_waitcnt vmcnt(4) lgkmcnt(0)
    s_barrier
    ds_read_b128 v[120:123], v140 offset:0
    ds_read_b64_tr_b16 v[216:217], v149 offset:0
    ds_read_b64_tr_b16 v[218:219], v149 offset:768
    ds_read_b128 v[220:223], v7 offset:896
    v_mfma_f32_32x32x16_bf16 v[168:183], v[116:119], v[228:231], v[168:183]
    v_mfma_f32_32x32x16_bf16 v[184:199], v[232:235], v[116:119], v[184:199]
    s_add_u32 m0, s63, 128032
    s_nop 0
    buffer_load_dwordx4 v158, s[20:23], s67 offen lds
    ds_read_b128 v[124:127], v141 offset:0
    ds_read_b64_tr_b16 v[228:229], v149 offset:3072
    ds_read_b64_tr_b16 v[230:231], v149 offset:3840
    ds_read_b128 v[232:235], v7 offset:928
    s_waitcnt lgkmcnt(4)
    v_mfma_f32_32x32x16_bf16 v[168:183], v[120:123], v[216:219], v[168:183]
    v_mfma_f32_32x32x16_bf16 v[184:199], v[220:223], v[120:123], v[184:199]
    s_add_u32 m0, s63, 129056
    s_nop 0
    buffer_load_dwordx4 v159, s[20:23], s67 offen lds
    ds_read_b128 v[128:131], v142 offset:0
    ds_read_b64_tr_b16 v[216:217], v149 offset:6144
    ds_read_b64_tr_b16 v[218:219], v149 offset:6912
    ds_read_b128 v[220:223], v7 offset:960
    s_waitcnt lgkmcnt(4)
    v_mfma_f32_32x32x16_bf16 v[168:183], v[124:127], v[228:231], v[168:183]
    v_mfma_f32_32x32x16_bf16 v[184:199], v[232:235], v[124:127], v[184:199]
    s_add_u32 s67, s14, 10
    s_and_b32 s67, s67, 7
    s_mul_i32 s67, s67, 176128
    s_add_u32 s67, s67, s65
    s_add_u32 m0, s63, 12320
    s_nop 0
    buffer_load_dwordx4 v157, s[20:23], s67 offen lds
    ds_read_b128 v[132:135], v143 offset:0
    ds_read_b64_tr_b16 v[228:229], v149 offset:9216
    ds_read_b64_tr_b16 v[230:231], v149 offset:9984
    ds_read_b128 v[232:235], v7 offset:992
    s_waitcnt lgkmcnt(4)
    v_mfma_f32_32x32x16_bf16 v[168:183], v[128:131], v[216:219], v[168:183]
    v_mfma_f32_32x32x16_bf16 v[184:199], v[220:223], v[128:131], v[184:199]
    s_add_u32 m0, s63, 13344
    s_nop 0
    buffer_load_dwordx4 v158, s[20:23], s67 offen lds
    s_waitcnt vmcnt(5) lgkmcnt(0)
    s_barrier
    ds_read_b64_tr_b16 v[216:217], v152 offset:28672
    ds_read_b64_tr_b16 v[218:219], v152 offset:29440
    ds_read_b64_tr_b16 v[220:221], v152 offset:28704
    ds_read_b64_tr_b16 v[222:223], v152 offset:29472
    ds_read_b64_tr_b16 v[224:225], v152 offset:28736
    ds_read_b64_tr_b16 v[226:227], v152 offset:29504
    v_mfma_f32_32x32x16_bf16 v[168:183], v[132:135], v[228:231], v[168:183]
    v_mfma_f32_32x32x16_bf16 v[184:199], v[232:235], v[132:135], v[184:199]
    s_add_u32 m0, s63, 14368
    s_nop 0
    buffer_load_dwordx4 v159, s[20:23], s67 offen lds
    s_lshl_b32 s69, s12, 2
    s_add_u32 s69, s69, s15
    s_lshl_b32 s70, s69, 10
    s_lshl_b32 s71, s13, 17
    s_add_u32 s71, s71, s70
    s_add_u32 s71, s71, 4194304
    v_and_b32 v3, 15, v1
    v_lshl_add_u32 v3, v6, 4, v3
    v_lshlrev_b32 v3, 4, v3
    v_bfe_u32 v4, v1, 4, 1
    v_lshl_add_u32 v248, v4, 16, v3
    v_cvt_pk_bf16_f32 v240, v168, v169
    v_cvt_pk_bf16_f32 v241, v170, v171
    v_cvt_pk_bf16_f32 v242, v172, v173
    v_cvt_pk_bf16_f32 v243, v174, v175
    v_cvt_pk_bf16_f32 v244, v176, v177
    v_cvt_pk_bf16_f32 v245, v178, v179
    v_cvt_pk_bf16_f32 v246, v180, v181
    v_cvt_pk_bf16_f32 v247, v182, v183
    v_mul_f32 v4, 0x3fb8aa3b, v184
    v_exp_f32 v0, v4
    v_exp_f32 v4, -v4
    s_lshl_b32 s68, s15, 7
    v_add_f32 v0, 1.0, v0
    v_add_f32 v4, 1.0, v4
    v_lshlrev_b32 v250, 2, v5
    v_rcp_f32 v249, v4
    v_min_f32 v0, 0x7f000000, v0
    s_add_u32 s68, s68, 131072
    v_add_u32 v7, s68, v250
    s_and_b32 s72, s13, 7
    s_lshl_b32 s72, s72, 13
    s_lshl_b32 s70, s69, 7
    s_add_u32 s72, s72, s70
    s_add_u32 s72, s72, 14680064
    ds_write_b32 v7, v0 offset:13312
    s_waitcnt lgkmcnt(0)
    ds_read_b64_tr_b16 v[228:229], v152 offset:31744
    ds_read_b64_tr_b16 v[230:231], v152 offset:32512
    ds_read_b64_tr_b16 v[232:233], v152 offset:31776
    ds_read_b64_tr_b16 v[234:235], v152 offset:32544
    ds_read_b64_tr_b16 v[236:237], v152 offset:31808
    ds_read_b64_tr_b16 v[238:239], v152 offset:32576
    s_waitcnt lgkmcnt(6)
    v_mfma_f32_32x32x16_bf16 v[168:183], v[216:219], v[8:11], 0
    v_mfma_f32_32x32x16_bf16 v[184:199], v[220:223], v[8:11], 0
    v_mfma_f32_32x32x16_bf16 v[200:215], v[224:227], v[8:11], 0
    ds_read_b64_tr_b16 v[216:217], v152 offset:34816
    ds_read_b64_tr_b16 v[218:219], v152 offset:35584
    ds_read_b64_tr_b16 v[220:221], v152 offset:34848
    ds_read_b64_tr_b16 v[222:223], v152 offset:35616
    ds_read_b64_tr_b16 v[224:225], v152 offset:34880
    ds_read_b64_tr_b16 v[226:227], v152 offset:35648
    s_waitcnt lgkmcnt(6)
    v_mfma_f32_32x32x16_bf16 v[168:183], v[228:231], v[12:15], v[168:183]
    v_mfma_f32_32x32x16_bf16 v[184:199], v[232:235], v[12:15], v[184:199]
    v_mfma_f32_32x32x16_bf16 v[200:215], v[236:239], v[12:15], v[200:215]
    buffer_store_dwordx4 v[240:243], v248, s[24:27], s71 offen offset:0 sc1
    s_add_u32 s67, s14, 11
    s_and_b32 s67, s67, 7
    s_mul_i32 s67, s67, 176128
    s_add_u32 s67, s67, s65
    s_add_u32 m0, s63, 40992
    s_nop 0
    buffer_load_dwordx4 v157, s[20:23], s67 offen lds
    s_and_b32 s30, s2, 7
    s_lshr_b32 s31, s2, 3
    s_lshl_b32 s4, s30, 2
    s_lshr_b32 s32, s31, 3
    s_add_u32 s4, s4, s32
    s_and_b32 s5, s31, 7
    s_and_b32 s38, s3, 3
    s_lshr_b32 s39, s3, 2
    s_lshl_b32 s33, s4, 16
    s_lshl_b32 s6, s5, 13
    s_add_u32 s6, s6, s33
    s_lshl_b32 s7, s38, 1
    s_lshl_b32 s8, s3, 13
    s_add_u32 s8, s8, s33
    s_add_u32 s9, s8, 4194304
    s_add_u32 s8, s8, 2097152
    s_add_u32 s10, s8, 4096
    s_add_u32 s11, s9, 4096
    s_add_u32 s35, s7, 7
    s_and_b32 s35, s35, 7
    s_xor_b32 s35, s35, s39
    s_lshl_b32 s36, s5, 3
    s_add_u32 s35, s35, s36
    s_mov_b32 s74, 0xffff
    s_mov_b32 s75, 0xffff
    ds_read_b64_tr_b16 v[228:229], v152 offset:37888
    ds_read_b64_tr_b16 v[230:231], v152 offset:38656
    ds_read_b64_tr_b16 v[232:233], v152 offset:37920
    ds_read_b64_tr_b16 v[234:235], v152 offset:38688
    ds_read_b64_tr_b16 v[236:237], v152 offset:37952
    ds_read_b64_tr_b16 v[238:239], v152 offset:38720
    s_waitcnt lgkmcnt(6)
    v_mfma_f32_32x32x16_bf16 v[168:183], v[216:219], v[16:19], v[168:183]
    v_mfma_f32_32x32x16_bf16 v[184:199], v[220:223], v[16:19], v[184:199]
    v_mfma_f32_32x32x16_bf16 v[200:215], v[224:227], v[16:19], v[200:215]
    buffer_store_dwordx4 v[244:247], v248, s[24:27], s71 offen offset:512 sc1
    s_add_u32 m0, s63, 42016
    s_nop 0
    buffer_load_dwordx4 v158, s[20:23], s67 offen lds
    v_lshrrev_b32 v136, 5, v1
    v_and_b32 v137, 15, v1
    v_lshl_add_u32 v3, v136, 4, v137
    v_lshlrev_b32 v3, 4, v3
    v_and_b32 v136, 27, v1
    v_cmp_eq_u32 vcc, 16, v136
    v_and_b32 v6, 31, v1
    v_lshlrev_b32 v6, 2, v6
    v_mov_b32 v136, 0x3f803f80
    v_cndmask_b32 v136, 0, v136, vcc
    v_lshlrev_b32 v138, 2, v137
    v_mov_b32 v137, v136
    s_lshr_b32 s30, s4, 2
    s_lshl_b32 s30, s30, 7
    s_lshr_b32 s31, s4, 1
    s_lshl_b32 s31, s31, 7
    v_and_b32 v139, 16, v1
    v_lshl_add_u32 v139, v139, 6, s30
    v_cmp_gt_u32 vcc, 32, v1
    v_mov_b32 v140, s31
    s_lshl_b32 s36, s35, 7
    v_cndmask_b32 v139, v140, v139, vcc
    v_add_u32 v138, v138, v139
    s_lshl_b32 s30, s30, 6
    s_add_u32 s36, s36, s30
    s_add_u32 s36, s36, 14680064
    s_mov_b32 s60, 14745600
    s_waitcnt vmcnt(7) lgkmcnt(0)
    s_barrier
    ds_read_b64_tr_b16 v[216:217], v153 offset:0
    ds_read_b64_tr_b16 v[218:219], v153 offset:768
    ds_read_b64_tr_b16 v[220:221], v153 offset:32
    ds_read_b64_tr_b16 v[222:223], v153 offset:800
    ds_read_b64_tr_b16 v[224:225], v153 offset:64
    ds_read_b64_tr_b16 v[226:227], v153 offset:832
    v_mfma_f32_32x32x16_bf16 v[168:183], v[228:231], v[20:23], v[168:183]
    v_mfma_f32_32x32x16_bf16 v[184:199], v[232:235], v[20:23], v[184:199]
    v_mfma_f32_32x32x16_bf16 v[200:215], v[236:239], v[20:23], v[200:215]
    buffer_store_dword v249, v250, s[24:27], s72 offen sc1
    s_add_u32 m0, s63, 43040
    s_nop 0
    buffer_load_dwordx4 v159, s[20:23], s67 offen lds
    s_and_b32 s59, s2, 7
    s_lshr_b32 s53, s2, 3
    s_lshl_b32 s52, s59, 2
    s_and_b32 s59, s53, 3
    s_add_u32 s52, s52, s59
    s_lshr_b32 s53, s53, 2
    s_and_b32 s54, s3, 3
    s_lshr_b32 s55, s3, 2
    s_lshl_b32 s52, s52, 1
    s_add_u32 s52, s52, s55
    s_mul_i32 s56, s52, 86
    s_add_u32 s56, s56, s54
    s_lshl_b32 s56, s56, 10
    s_add_u32 s56, s56, 8388608
    s_lshl_b32 s57, s54, 14
    s_lshl_b32 s59, s55, 13
    s_add_u32 s57, s57, s59
    s_lshl_b32 s59, s53, 7
    s_add_u32 s57, s57, s59
    s_mul_i32 s58, s54, 10240
    s_lshl_b32 s59, s55, 10
    s_add_u32 s58, s58, s59
    v_lshrrev_b32 v140, 7, v2
    v_lshrrev_b32 v141, 3, v2
    v_and_b32 v141, 32, v141
    v_xor_b32 v141, v141, v2
    v_and_b32 v141, 0x70, v141
    v_lshl_add_u32 v1, v140, 10, v141
    ds_read_b64_tr_b16 v[228:229], v153 offset:3072
    ds_read_b64_tr_b16 v[230:231], v153 offset:3840
    ds_read_b64_tr_b16 v[232:233], v153 offset:3104
    ds_read_b64_tr_b16 v[234:235], v153 offset:3872
    ds_read_b64_tr_b16 v[236:237], v153 offset:3136
    ds_read_b64_tr_b16 v[238:239], v153 offset:3904
    s_waitcnt lgkmcnt(6)
    v_mfma_f32_32x32x16_bf16 v[168:183], v[216:219], v[24:27], v[168:183]
    v_mfma_f32_32x32x16_bf16 v[184:199], v[220:223], v[24:27], v[184:199]
    v_mfma_f32_32x32x16_bf16 v[200:215], v[224:227], v[24:27], v[200:215]
    s_add_u32 s67, s14, 12
    s_and_b32 s67, s67, 7
    s_mul_i32 s67, s67, 176128
    s_add_u32 s67, s67, s65
    s_add_u32 m0, s63, 69664
    s_nop 0
    buffer_load_dwordx4 v157, s[20:23], s67 offen lds
    ds_read_b64_tr_b16 v[216:217], v153 offset:6144
    ds_read_b64_tr_b16 v[218:219], v153 offset:6912
    ds_read_b64_tr_b16 v[220:221], v153 offset:6176
    ds_read_b64_tr_b16 v[222:223], v153 offset:6944
    ds_read_b64_tr_b16 v[224:225], v153 offset:6208
    ds_read_b64_tr_b16 v[226:227], v153 offset:6976
    s_waitcnt lgkmcnt(6)
    v_mfma_f32_32x32x16_bf16 v[168:183], v[228:231], v[28:31], v[168:183]
    v_mfma_f32_32x32x16_bf16 v[184:199], v[232:235], v[28:31], v[184:199]
    v_mfma_f32_32x32x16_bf16 v[200:215], v[236:239], v[28:31], v[200:215]
    s_add_u32 m0, s63, 70688
    s_nop 0
    buffer_load_dwordx4 v158, s[20:23], s67 offen lds
    ds_read_b64_tr_b16 v[228:229], v153 offset:9216
    ds_read_b64_tr_b16 v[230:231], v153 offset:9984
    ds_read_b64_tr_b16 v[232:233], v153 offset:9248
    ds_read_b64_tr_b16 v[234:235], v153 offset:10016
    ds_read_b64_tr_b16 v[236:237], v153 offset:9280
    ds_read_b64_tr_b16 v[238:239], v153 offset:10048
    s_waitcnt lgkmcnt(6)
    v_mfma_f32_32x32x16_bf16 v[168:183], v[216:219], v[32:35], v[168:183]
    v_mfma_f32_32x32x16_bf16 v[184:199], v[220:223], v[32:35], v[184:199]
    v_mfma_f32_32x32x16_bf16 v[200:215], v[224:227], v[32:35], v[200:215]
    s_add_u32 m0, s63, 71712
    s_nop 0
    buffer_load_dwordx4 v159, s[20:23], s67 offen lds
    s_waitcnt vmcnt(4)
    s_waitcnt lgkmcnt(0)
    s_barrier
    ds_read_b64_tr_b16 v[216:217], v151 offset:0
    ds_read_b64_tr_b16 v[218:219], v151 offset:768
    ds_read_b64_tr_b16 v[220:221], v151 offset:32
    ds_read_b64_tr_b16 v[222:223], v151 offset:800
    ds_read_b64_tr_b16 v[224:225], v151 offset:64
    ds_read_b64_tr_b16 v[226:227], v151 offset:832
    v_mfma_f32_32x32x16_bf16 v[168:183], v[228:231], v[36:39], v[168:183]
    v_mfma_f32_32x32x16_bf16 v[184:199], v[232:235], v[36:39], v[184:199]
    v_mfma_f32_32x32x16_bf16 v[200:215], v[236:239], v[36:39], v[200:215]
    s_add_u32 s67, s14, 13
    s_and_b32 s67, s67, 7
    s_mul_i32 s67, s67, 176128
    s_add_u32 s67, s67, s65
    s_add_u32 m0, s63, 98336
    s_nop 0
    buffer_load_dwordx4 v157, s[20:23], s67 offen lds
    ds_read_b64_tr_b16 v[228:229], v151 offset:3072
    ds_read_b64_tr_b16 v[230:231], v151 offset:3840
    ds_read_b64_tr_b16 v[232:233], v151 offset:3104
    ds_read_b64_tr_b16 v[234:235], v151 offset:3872
    ds_read_b64_tr_b16 v[236:237], v151 offset:3136
    ds_read_b64_tr_b16 v[238:239], v151 offset:3904
    s_waitcnt lgkmcnt(6)
    v_mfma_f32_32x32x16_bf16 v[168:183], v[216:219], v[40:43], v[168:183]
    v_mfma_f32_32x32x16_bf16 v[184:199], v[220:223], v[40:43], v[184:199]
    v_mfma_f32_32x32x16_bf16 v[200:215], v[224:227], v[40:43], v[200:215]
    s_add_u32 m0, s63, 99360
    s_nop 0
    buffer_load_dwordx4 v158, s[20:23], s67 offen lds
    ds_read_b64_tr_b16 v[216:217], v151 offset:6144
    ds_read_b64_tr_b16 v[218:219], v151 offset:6912
    ds_read_b64_tr_b16 v[220:221], v151 offset:6176
    ds_read_b64_tr_b16 v[222:223], v151 offset:6944
    ds_read_b64_tr_b16 v[224:225], v151 offset:6208
    ds_read_b64_tr_b16 v[226:227], v151 offset:6976
    s_waitcnt lgkmcnt(6)
    v_mfma_f32_32x32x16_bf16 v[168:183], v[228:231], v[44:47], v[168:183]
    v_mfma_f32_32x32x16_bf16 v[184:199], v[232:235], v[44:47], v[184:199]
    v_mfma_f32_32x32x16_bf16 v[200:215], v[236:239], v[44:47], v[200:215]
    s_add_u32 m0, s63, 100384
    s_nop 0
    buffer_load_dwordx4 v159, s[20:23], s67 offen lds
    ds_read_b64_tr_b16 v[228:229], v151 offset:9216
    ds_read_b64_tr_b16 v[230:231], v151 offset:9984
    ds_read_b64_tr_b16 v[232:233], v151 offset:9248
    ds_read_b64_tr_b16 v[234:235], v151 offset:10016
    ds_read_b64_tr_b16 v[236:237], v151 offset:9280
    ds_read_b64_tr_b16 v[238:239], v151 offset:10048
    s_waitcnt lgkmcnt(6)
    v_mfma_f32_32x32x16_bf16 v[168:183], v[216:219], v[48:51], v[168:183]
    v_mfma_f32_32x32x16_bf16 v[184:199], v[220:223], v[48:51], v[184:199]
    v_mfma_f32_32x32x16_bf16 v[200:215], v[224:227], v[48:51], v[200:215]
    s_add_u32 s67, s14, 14
    s_and_b32 s67, s67, 7
    s_mul_i32 s67, s67, 176128
    s_add_u32 s67, s67, s65
    s_add_u32 m0, s63, 127008
    s_nop 0
    buffer_load_dwordx4 v157, s[20:23], s67 offen lds
    s_lshl_b32 s70, s69, 5
    s_add_u32 s70, s70, s13
    s_lshl_b32 s62, s70, 3
    s_add_u32 s62, s62, 14749700
    s_lshl_b32 s70, s35, 6
    s_add_u32 s70, s70, s4
    s_lshl_b32 s28, s70, 2
    s_add_u32 s28, s28, 14749824
    s_lshl_b32 s70, s35, 5
    s_add_u32 s70, s70, s4
    s_lshl_b32 s70, s70, 10
    s_add_u32 s70, s70, 6291456
    v_mov_b64 v[160:161], -1
    v_mov_b64 v[162:163], -1
    buffer_store_dwordx4 v[160:163], v2, s[24:27], s70 offen sc1
    s_waitcnt vmcnt(8) lgkmcnt(0)
    s_barrier
    ds_read_b64_tr_b16 v[216:217], v151 offset:28672
    ds_read_b64_tr_b16 v[218:219], v151 offset:29440
    ds_read_b64_tr_b16 v[220:221], v151 offset:28704
    ds_read_b64_tr_b16 v[222:223], v151 offset:29472
    ds_read_b64_tr_b16 v[224:225], v151 offset:28736
    ds_read_b64_tr_b16 v[226:227], v151 offset:29504
    v_mfma_f32_32x32x16_bf16 v[168:183], v[228:231], v[52:55], v[168:183]
    v_mfma_f32_32x32x16_bf16 v[184:199], v[232:235], v[52:55], v[184:199]
    v_mfma_f32_32x32x16_bf16 v[200:215], v[236:239], v[52:55], v[200:215]
    s_add_u32 m0, s63, 128032
    s_nop 0
    buffer_load_dwordx4 v158, s[20:23], s67 offen lds
    ds_read_b64_tr_b16 v[228:229], v151 offset:31744
    ds_read_b64_tr_b16 v[230:231], v151 offset:32512
    ds_read_b64_tr_b16 v[232:233], v151 offset:31776
    ds_read_b64_tr_b16 v[234:235], v151 offset:32544
    ds_read_b64_tr_b16 v[236:237], v151 offset:31808
    ds_read_b64_tr_b16 v[238:239], v151 offset:32576
    s_waitcnt lgkmcnt(6)
    v_mfma_f32_32x32x16_bf16 v[168:183], v[216:219], v[56:59], v[168:183]
    v_mfma_f32_32x32x16_bf16 v[184:199], v[220:223], v[56:59], v[184:199]
    v_mfma_f32_32x32x16_bf16 v[200:215], v[224:227], v[56:59], v[200:215]
    s_add_u32 m0, s63, 129056
    s_nop 0
    buffer_load_dwordx4 v159, s[20:23], s67 offen lds
    ds_read_b64_tr_b16 v[216:217], v151 offset:34816
    ds_read_b64_tr_b16 v[218:219], v151 offset:35584
    ds_read_b64_tr_b16 v[220:221], v151 offset:34848
    ds_read_b64_tr_b16 v[222:223], v151 offset:35616
    ds_read_b64_tr_b16 v[224:225], v151 offset:34880
    ds_read_b64_tr_b16 v[226:227], v151 offset:35648
    s_waitcnt lgkmcnt(6)
    v_mfma_f32_32x32x16_bf16 v[168:183], v[228:231], v[60:63], v[168:183]
    v_mfma_f32_32x32x16_bf16 v[184:199], v[232:235], v[60:63], v[184:199]
    v_mfma_f32_32x32x16_bf16 v[200:215], v[236:239], v[60:63], v[200:215]
    s_add_u32 s67, s14, 15
    s_and_b32 s67, s67, 7
    s_mul_i32 s67, s67, 176128
    s_add_u32 s67, s67, s65
    s_add_u32 m0, s63, 12320
    s_nop 0
    buffer_load_dwordx4 v157, s[20:23], s67 offen lds
    ds_read_b64_tr_b16 v[228:229], v151 offset:37888
    ds_read_b64_tr_b16 v[230:231], v151 offset:38656
    ds_read_b64_tr_b16 v[232:233], v151 offset:37920
    ds_read_b64_tr_b16 v[234:235], v151 offset:38688
    ds_read_b64_tr_b16 v[236:237], v151 offset:37952
    ds_read_b64_tr_b16 v[238:239], v151 offset:38720
    s_waitcnt lgkmcnt(6)
    v_mfma_f32_32x32x16_bf16 v[168:183], v[216:219], v[64:67], v[168:183]
    v_mfma_f32_32x32x16_bf16 v[184:199], v[220:223], v[64:67], v[184:199]
    v_mfma_f32_32x32x16_bf16 v[200:215], v[224:227], v[64:67], v[200:215]
    s_add_u32 m0, s63, 13344
    s_nop 0
    buffer_load_dwordx4 v158, s[20:23], s67 offen lds
    s_waitcnt vmcnt(9) lgkmcnt(0)
    s_barrier
    ds_read_b64_tr_b16 v[216:217], v152 offset:0
    ds_read_b64_tr_b16 v[218:219], v152 offset:768
    ds_read_b64_tr_b16 v[220:221], v152 offset:32
    ds_read_b64_tr_b16 v[222:223], v152 offset:800
    ds_read_b64_tr_b16 v[224:225], v152 offset:64
    ds_read_b64_tr_b16 v[226:227], v152 offset:832
    v_mfma_f32_32x32x16_bf16 v[168:183], v[228:231], v[68:71], v[168:183]
    v_mfma_f32_32x32x16_bf16 v[184:199], v[232:235], v[68:71], v[184:199]
    v_mfma_f32_32x32x16_bf16 v[200:215], v[236:239], v[68:71], v[200:215]
    s_add_u32 m0, s63, 14368
    s_nop 0
    buffer_load_dwordx4 v159, s[20:23], s67 offen lds
    ds_read_b64_tr_b16 v[228:229], v152 offset:3072
    ds_read_b64_tr_b16 v[230:231], v152 offset:3840
    ds_read_b64_tr_b16 v[232:233], v152 offset:3104
    ds_read_b64_tr_b16 v[234:235], v152 offset:3872
    ds_read_b64_tr_b16 v[236:237], v152 offset:3136
    ds_read_b64_tr_b16 v[238:239], v152 offset:3904
    s_waitcnt lgkmcnt(6)
    v_mfma_f32_32x32x16_bf16 v[168:183], v[216:219], v[72:75], v[168:183]
    v_mfma_f32_32x32x16_bf16 v[184:199], v[220:223], v[72:75], v[184:199]
    v_mfma_f32_32x32x16_bf16 v[200:215], v[224:227], v[72:75], v[200:215]
    buffer_load_dword v139, v138, s[24:27], s60 offen sc1
    ds_read_b64_tr_b16 v[216:217], v152 offset:6144
    ds_read_b64_tr_b16 v[218:219], v152 offset:6912
    ds_read_b64_tr_b16 v[220:221], v152 offset:6176
    ds_read_b64_tr_b16 v[222:223], v152 offset:6944
    ds_read_b64_tr_b16 v[224:225], v152 offset:6208
    ds_read_b64_tr_b16 v[226:227], v152 offset:6976
    s_waitcnt lgkmcnt(6)
    v_mfma_f32_32x32x16_bf16 v[168:183], v[228:231], v[76:79], v[168:183]
    v_mfma_f32_32x32x16_bf16 v[184:199], v[232:235], v[76:79], v[184:199]
    v_mfma_f32_32x32x16_bf16 v[200:215], v[236:239], v[76:79], v[200:215]
    ds_read_b64_tr_b16 v[228:229], v152 offset:9216
    ds_read_b64_tr_b16 v[230:231], v152 offset:9984
    ds_read_b64_tr_b16 v[232:233], v152 offset:9248
    ds_read_b64_tr_b16 v[234:235], v152 offset:10016
    ds_read_b64_tr_b16 v[236:237], v152 offset:9280
    ds_read_b64_tr_b16 v[238:239], v152 offset:10048
    s_waitcnt lgkmcnt(6)
    v_mfma_f32_32x32x16_bf16 v[168:183], v[216:219], v[80:83], v[168:183]
    v_mfma_f32_32x32x16_bf16 v[184:199], v[220:223], v[80:83], v[184:199]
    v_mfma_f32_32x32x16_bf16 v[200:215], v[224:227], v[80:83], v[200:215]
    s_waitcnt vmcnt(1) lgkmcnt(0)
    s_barrier
    s_setprio 1
    ds_read_b64_tr_b16 v[216:217], v152 offset:28672
    ds_read_b64_tr_b16 v[218:219], v152 offset:29440
    ds_read_b64_tr_b16 v[220:221], v152 offset:28704
    ds_read_b64_tr_b16 v[222:223], v152 offset:29472
    ds_read_b64_tr_b16 v[224:225], v152 offset:28736
    ds_read_b64_tr_b16 v[226:227], v152 offset:29504
    v_mfma_f32_32x32x16_bf16 v[168:183], v[228:231], v[84:87], v[168:183]
    v_mfma_f32_32x32x16_bf16 v[184:199], v[232:235], v[84:87], v[184:199]
    v_mfma_f32_32x32x16_bf16 v[200:215], v[236:239], v[84:87], v[200:215]
    ds_read_b64_tr_b16 v[228:229], v152 offset:31744
    ds_read_b64_tr_b16 v[230:231], v152 offset:32512
    ds_read_b64_tr_b16 v[232:233], v152 offset:31776
    ds_read_b64_tr_b16 v[234:235], v152 offset:32544
    ds_read_b64_tr_b16 v[236:237], v152 offset:31808
    ds_read_b64_tr_b16 v[238:239], v152 offset:32576
    s_waitcnt lgkmcnt(6)
    v_mfma_f32_32x32x16_bf16 v[168:183], v[216:219], v[88:91], v[168:183]
    v_mfma_f32_32x32x16_bf16 v[184:199], v[220:223], v[88:91], v[184:199]
    v_mfma_f32_32x32x16_bf16 v[200:215], v[224:227], v[88:91], v[200:215]
    s_waitcnt vmcnt(0)
    v_cmp_ne_u32 vcc, s100, v139
    s_cbranch_vccnz retry_9
back_10:
    ds_read_b64_tr_b16 v[216:217], v152 offset:34816
    ds_read_b64_tr_b16 v[218:219], v152 offset:35584
    ds_read_b64_tr_b16 v[220:221], v152 offset:34848
    ds_read_b64_tr_b16 v[222:223], v152 offset:35616
    ds_read_b64_tr_b16 v[224:225], v152 offset:34880
    ds_read_b64_tr_b16 v[226:227], v152 offset:35648
    s_waitcnt lgkmcnt(6)
    v_mfma_f32_32x32x16_bf16 v[168:183], v[228:231], v[92:95], v[168:183]
    v_mfma_f32_32x32x16_bf16 v[184:199], v[232:235], v[92:95], v[184:199]
    v_mfma_f32_32x32x16_bf16 v[200:215], v[236:239], v[92:95], v[200:215]
    ds_read_b64_tr_b16 v[228:229], v152 offset:37888
    ds_read_b64_tr_b16 v[230:231], v152 offset:38656
    ds_read_b64_tr_b16 v[232:233], v152 offset:37920
    ds_read_b64_tr_b16 v[234:235], v152 offset:38688
    ds_read_b64_tr_b16 v[236:237], v152 offset:37952
    ds_read_b64_tr_b16 v[238:239], v152 offset:38720
    s_waitcnt lgkmcnt(6)
    v_mfma_f32_32x32x16_bf16 v[168:183], v[216:219], v[96:99], v[168:183]
    v_mfma_f32_32x32x16_bf16 v[184:199], v[220:223], v[96:99], v[184:199]
    v_mfma_f32_32x32x16_bf16 v[200:215], v[224:227], v[96:99], v[200:215]
    ds_read_b64_tr_b16 v[216:217], v153 offset:0
    ds_read_b64_tr_b16 v[218:219], v153 offset:768
    ds_read_b64_tr_b16 v[220:221], v153 offset:32
    ds_read_b64_tr_b16 v[222:223], v153 offset:800
    ds_read_b64_tr_b16 v[224:225], v153 offset:64
    ds_read_b64_tr_b16 v[226:227], v153 offset:832
    s_waitcnt lgkmcnt(6)
    v_mfma_f32_32x32x16_bf16 v[168:183], v[228:231], v[100:103], v[168:183]
    v_mfma_f32_32x32x16_bf16 v[184:199], v[232:235], v[100:103], v[184:199]
    v_mfma_f32_32x32x16_bf16 v[200:215], v[236:239], v[100:103], v[200:215]
    ds_read_b64_tr_b16 v[228:229], v153 offset:3072
    ds_read_b64_tr_b16 v[230:231], v153 offset:3840
    ds_read_b64_tr_b16 v[232:233], v153 offset:3104
    ds_read_b64_tr_b16 v[234:235], v153 offset:3872
    ds_read_b64_tr_b16 v[236:237], v153 offset:3136
    ds_read_b64_tr_b16 v[238:239], v153 offset:3904
    s_waitcnt lgkmcnt(6)
    v_mfma_f32_32x32x16_bf16 v[168:183], v[216:219], v[104:107], v[168:183]
    v_mfma_f32_32x32x16_bf16 v[184:199], v[220:223], v[104:107], v[184:199]
    v_mfma_f32_32x32x16_bf16 v[200:215], v[224:227], v[104:107], v[200:215]
    ds_read_b64_tr_b16 v[216:217], v153 offset:6144
    ds_read_b64_tr_b16 v[218:219], v153 offset:6912
    ds_read_b64_tr_b16 v[220:221], v153 offset:6176
    ds_read_b64_tr_b16 v[222:223], v153 offset:6944
    ds_read_b64_tr_b16 v[224:225], v153 offset:6208
    ds_read_b64_tr_b16 v[226:227], v153 offset:6976
    s_waitcnt lgkmcnt(6)
    v_mfma_f32_32x32x16_bf16 v[168:183], v[228:231], v[108:111], v[168:183]
    v_mfma_f32_32x32x16_bf16 v[184:199], v[232:235], v[108:111], v[184:199]
    v_mfma_f32_32x32x16_bf16 v[200:215], v[236:239], v[108:111], v[200:215]
    ds_read_b64_tr_b16 v[228:229], v153 offset:9216
    ds_read_b64_tr_b16 v[230:231], v153 offset:9984
    ds_read_b64_tr_b16 v[232:233], v153 offset:9248
    ds_read_b64_tr_b16 v[234:235], v153 offset:10016
    ds_read_b64_tr_b16 v[236:237], v153 offset:9280
    ds_read_b64_tr_b16 v[238:239], v153 offset:10048
    s_waitcnt lgkmcnt(6)
    v_mfma_f32_32x32x16_bf16 v[168:183], v[216:219], v[112:115], v[168:183]
    v_mfma_f32_32x32x16_bf16 v[184:199], v[220:223], v[112:115], v[184:199]
    v_mfma_f32_32x32x16_bf16 v[200:215], v[224:227], v[112:115], v[200:215]
    buffer_load_dword v6, v6, s[24:27], s36 offen sc1
    s_add_u32 s34, s7, 0
    s_and_b32 s34, s34, 7
    s_xor_b32 s34, s34, s39
    s_lshl_b32 s34, s34, 10
    s_add_u32 s34, s34, s6
    buffer_load_dwordx4 v[160:163], v2, s[24:27], s34 offen sc1
    buffer_load_dwordx4 v[8:11], v2, s[24:27], s8 offen offset:0 sc1
    ds_read_b64_tr_b16 v[216:217], v151 offset:0
    ds_read_b64_tr_b16 v[218:219], v151 offset:768
    ds_read_b64_tr_b16 v[220:221], v151 offset:32
    ds_read_b64_tr_b16 v[222:223], v151 offset:800
    ds_read_b64_tr_b16 v[224:225], v151 offset:64
    ds_read_b64_tr_b16 v[226:227], v151 offset:832
    s_waitcnt lgkmcnt(6)
    v_mfma_f32_32x32x16_bf16 v[168:183], v[228:231], v[116:119], v[168:183]
    v_mfma_f32_32x32x16_bf16 v[184:199], v[232:235], v[116:119], v[184:199]
    v_mfma_f32_32x32x16_bf16 v[200:215], v[236:239], v[116:119], v[200:215]
    buffer_load_dwordx4 v[12:15], v2, s[24:27], s8 offen offset:1024 sc1
    v_mov_b64 v[40:41], v[136:137]
    v_mov_b64 v[42:43], v[136:137]
    v_mov_b64 v[44:45], v[136:137]
    v_mov_b64 v[46:47], v[136:137]
    s_mov_b64 exec, s[74:75]
    buffer_load_dwordx4 v[40:43], v3, s[24:27], s9 offen offset:0 sc1
    buffer_load_dwordx4 v[44:47], v3, s[24:27], s9 offen offset:512 sc1
    s_mov_b64 exec, -1
    ds_read_b64_tr_b16 v[228:229], v151 offset:3072
    ds_read_b64_tr_b16 v[230:231], v151 offset:3840
    ds_read_b64_tr_b16 v[232:233], v151 offset:3104
    ds_read_b64_tr_b16 v[234:235], v151 offset:3872
    ds_read_b64_tr_b16 v[236:237], v151 offset:3136
    ds_read_b64_tr_b16 v[238:239], v151 offset:3904
    s_waitcnt lgkmcnt(6)
    v_mfma_f32_32x32x16_bf16 v[168:183], v[216:219], v[120:123], v[168:183]
    v_mfma_f32_32x32x16_bf16 v[184:199], v[220:223], v[120:123], v[184:199]
    v_mfma_f32_32x32x16_bf16 v[200:215], v[224:227], v[120:123], v[200:215]
    buffer_load_dwordx4 v[16:19], v2, s[24:27], s8 offen offset:2048 sc1
    v_mov_b64 v[48:49], v[136:137]
    v_mov_b64 v[50:51], v[136:137]
    v_mov_b64 v[52:53], v[136:137]
    v_mov_b64 v[54:55], v[136:137]
    s_mov_b64 exec, s[74:75]
    buffer_load_dwordx4 v[48:51], v3, s[24:27], s9 offen offset:1024 sc1
    buffer_load_dwordx4 v[52:55], v3, s[24:27], s9 offen offset:1536 sc1
    s_mov_b64 exec, -1
    ds_read_b64_tr_b16 v[216:217], v151 offset:6144
    ds_read_b64_tr_b16 v[218:219], v151 offset:6912
    ds_read_b64_tr_b16 v[220:221], v151 offset:6176
    ds_read_b64_tr_b16 v[222:223], v151 offset:6944
    ds_read_b64_tr_b16 v[224:225], v151 offset:6208
    ds_read_b64_tr_b16 v[226:227], v151 offset:6976
    s_waitcnt lgkmcnt(6)
    v_mfma_f32_32x32x16_bf16 v[168:183], v[228:231], v[124:127], v[168:183]
    v_mfma_f32_32x32x16_bf16 v[184:199], v[232:235], v[124:127], v[184:199]
    v_mfma_f32_32x32x16_bf16 v[200:215], v[236:239], v[124:127], v[200:215]
    buffer_load_dwordx4 v[20:23], v2, s[24:27], s8 offen offset:3072 sc1
    v_mov_b64 v[56:57], v[136:137]
    v_mov_b64 v[58:59], v[136:137]
    v_mov_b64 v[60:61], v[136:137]
    v_mov_b64 v[62:63], v[136:137]
    s_mov_b64 exec, s[74:75]
    buffer_load_dwordx4 v[56:59], v3, s[24:27], s9 offen offset:2048 sc1
    buffer_load_dwordx4 v[60:63], v3, s[24:27], s9 offen offset:2560 sc1
    s_mov_b64 exec, -1
    ds_read_b64_tr_b16 v[228:229], v151 offset:9216
    ds_read_b64_tr_b16 v[230:231], v151 offset:9984
    ds_read_b64_tr_b16 v[232:233], v151 offset:9248
    ds_read_b64_tr_b16 v[234:235], v151 offset:10016
    ds_read_b64_tr_b16 v[236:237], v151 offset:9280
    ds_read_b64_tr_b16 v[238:239], v151 offset:10048
    s_waitcnt lgkmcnt(6)
    v_mfma_f32_32x32x16_bf16 v[168:183], v[216:219], v[128:131], v[168:183]
    v_mfma_f32_32x32x16_bf16 v[184:199], v[220:223], v[128:131], v[184:199]
    v_mfma_f32_32x32x16_bf16 v[200:215], v[224:227], v[128:131], v[200:215]
    buffer_load_dwordx4 v[24:27], v2, s[24:27], s10 offen offset:0 sc1
    v_mov_b64 v[64:65], v[136:137]
    v_mov_b64 v[66:67], v[136:137]
    v_mov_b64 v[68:69], v[136:137]
    v_mov_b64 v[70:71], v[136:137]
    s_mov_b64 exec, s[74:75]
    buffer_load_dwordx4 v[64:67], v3, s[24:27], s9 offen offset:3072 sc1
    buffer_load_dwordx4 v[68:71], v3, s[24:27], s9 offen offset:3584 sc1
    s_mov_b64 exec, -1
    s_waitcnt lgkmcnt(0)
    s_lshl_b32 s68, s3, 2
    s_add_u32 s68, s68, 155616
    v_mov_b32 v240, s68
    ds_write_b32 v240, v240
    v_mfma_f32_32x32x16_bf16 v[168:183], v[228:231], v[132:135], v[168:183]
    v_mfma_f32_32x32x16_bf16 v[184:199], v[232:235], v[132:135], v[184:199]
    v_mfma_f32_32x32x16_bf16 v[200:215], v[236:239], v[132:135], v[200:215]
    buffer_load_dwordx4 v[28:31], v2, s[24:27], s10 offen offset:1024 sc1
    v_mov_b64 v[72:73], v[136:137]
    v_mov_b64 v[74:75], v[136:137]
    v_mov_b64 v[76:77], v[136:137]
    v_mov_b64 v[78:79], v[136:137]
    s_mov_b64 exec, s[74:75]
    buffer_load_dwordx4 v[72:75], v3, s[24:27], s11 offen offset:0 sc1
    buffer_load_dwordx4 v[76:79], v3, s[24:27], s11 offen offset:512 sc1
    s_mov_b64 exec, -1
    s_mov_b32 s72, 0xbdd2d3e8
    s_mov_b32 s73, s72
    v_mov_b32 v4, 0xc0135761
    s_mul_i32 s70, s69, 86
    s_mul_i32 s71, s13, 6
    s_add_u32 s71, s71, 3
    s_add_u32 s70, s70, s71
    s_lshl_b32 s70, s70, 10
    s_add_u32 s70, s70, 8388608
    s_lshl_b32 s68, s69, 12
    s_add_u32 s68, s68, 14024704
    s_setprio 3
    s_cmp_ge_u32 s71, 86
    s_cselect_b32 s70, s68, s70
    v_pk_mul_f32 v[240:241], v[168:169], v[168:169]
    v_pk_mul_f32 v[242:243], v[170:171], v[170:171]
    v_pk_mul_f32 v[244:245], v[172:173], v[172:173]
    v_pk_mul_f32 v[246:247], v[174:175], v[174:175]
    v_pk_fma_f32 v[240:241], v[240:241], s[72:73], v[4:5] op_sel_hi:[1,1,0]
    v_pk_fma_f32 v[242:243], v[242:243], s[72:73], v[4:5] op_sel_hi:[1,1,0]
    v_pk_fma_f32 v[244:245], v[244:245], s[72:73], v[4:5] op_sel_hi:[1,1,0]
    v_pk_fma_f32 v[246:247], v[246:247], s[72:73], v[4:5] op_sel_hi:[1,1,0]
    v_pk_mul_f32 v[240:241], v[240:241], v[168:169]
    v_pk_mul_f32 v[242:243], v[242:243], v[170:171]
    v_pk_mul_f32 v[244:245], v[244:245], v[172:173]
    v_pk_mul_f32 v[246:247], v[246:247], v[174:175]
    v_exp_f32 v240, v240
    v_exp_f32 v241, v241
    v_exp_f32 v242, v242
    v_exp_f32 v243, v243
    v_exp_f32 v244, v244
    v_exp_f32 v245, v245
    v_exp_f32 v246, v246
    v_exp_f32 v247, v247
    v_pk_fma_f32 v[240:241], v[240:241], v[0:1], v[0:1] op_sel_hi:[1,0,0]
    v_pk_fma_f32 v[242:243], v[242:243], v[0:1], v[0:1] op_sel_hi:[1,0,0]
    v_pk_fma_f32 v[244:245], v[244:245], v[0:1], v[0:1] op_sel_hi:[1,0,0]
    v_pk_fma_f32 v[246:247], v[246:247], v[0:1], v[0:1] op_sel_hi:[1,0,0]
    v_rcp_f32 v240, v240
    v_rcp_f32 v241, v241
    v_rcp_f32 v242, v242
    v_rcp_f32 v243, v243
    v_rcp_f32 v244, v244
    v_rcp_f32 v245, v245
    v_rcp_f32 v246, v246
    v_rcp_f32 v247, v247
    v_pk_mul_f32 v[240:241], v[240:241], v[168:169]
    v_pk_mul_f32 v[242:243], v[242:243], v[170:171]
    v_pk_mul_f32 v[244:245], v[244:245], v[172:173]
    v_pk_mul_f32 v[246:247], v[246:247], v[174:175]
    v_pk_mul_f32 v[240:241], v[240:241], v[176:177]
    v_pk_mul_f32 v[242:243], v[242:243], v[178:179]
    v_pk_mul_f32 v[244:245], v[244:245], v[180:181]
    v_pk_mul_f32 v[246:247], v[246:247], v[182:183]
    v_cvt_pk_bf16_f32 v168, v240, v241
    v_cvt_pk_bf16_f32 v169, v242, v243
    v_cvt_pk_bf16_f32 v170, v244, v245
    v_cvt_pk_bf16_f32 v171, v246, v247
    buffer_store_dwordx4 v[168:171], v2, s[24:27], s70 offen offset:0 sc1
    buffer_load_dwordx4 v[32:35], v2, s[24:27], s10 offen offset:2048 sc1
    v_mov_b64 v[80:81], v[136:137]
    v_mov_b64 v[82:83], v[136:137]
    v_mov_b64 v[84:85], v[136:137]
    v_mov_b64 v[86:87], v[136:137]
    s_mov_b64 exec, s[74:75]
    buffer_load_dwordx4 v[80:83], v3, s[24:27], s11 offen offset:1024 sc1
    buffer_load_dwordx4 v[84:87], v3, s[24:27], s11 offen offset:1536 sc1
    s_mov_b64 exec, -1
    s_cmp_ge_u32 s71, 85
    s_cselect_b32 s70, s68, s70
    v_pk_mul_f32 v[248:249], v[184:185], v[184:185]
    v_pk_mul_f32 v[250:251], v[186:187], v[186:187]
    v_pk_mul_f32 v[252:253], v[188:189], v[188:189]
    v_pk_mul_f32 v[254:255], v[190:191], v[190:191]
    v_pk_fma_f32 v[248:249], v[248:249], s[72:73], v[4:5] op_sel_hi:[1,1,0]
    v_pk_fma_f32 v[250:251], v[250:251], s[72:73], v[4:5] op_sel_hi:[1,1,0]
    v_pk_fma_f32 v[252:253], v[252:253], s[72:73], v[4:5] op_sel_hi:[1,1,0]
    v_pk_fma_f32 v[254:255], v[254:255], s[72:73], v[4:5] op_sel_hi:[1,1,0]
    v_pk_mul_f32 v[248:249], v[248:249], v[184:185]
    v_pk_mul_f32 v[250:251], v[250:251], v[186:187]
    v_pk_mul_f32 v[252:253], v[252:253], v[188:189]
    v_pk_mul_f32 v[254:255], v[254:255], v[190:191]
    v_exp_f32 v248, v248
    v_exp_f32 v249, v249
    v_exp_f32 v250, v250
    v_exp_f32 v251, v251
    v_exp_f32 v252, v252
    v_exp_f32 v253, v253
    v_exp_f32 v254, v254
    v_exp_f32 v255, v255
    v_pk_fma_f32 v[248:249], v[248:249], v[0:1], v[0:1] op_sel_hi:[1,0,0]
    v_pk_fma_f32 v[250:251], v[250:251], v[0:1], v[0:1] op_sel_hi:[1,0,0]
    v_pk_fma_f32 v[252:253], v[252:253], v[0:1], v[0:1] op_sel_hi:[1,0,0]
    v_pk_fma_f32 v[254:255], v[254:255], v[0:1], v[0:1] op_sel_hi:[1,0,0]
    v_rcp_f32 v248, v248
    v_rcp_f32 v249, v249
    v_rcp_f32 v250, v250
    v_rcp_f32 v251, v251
    v_rcp_f32 v252, v252
    v_rcp_f32 v253, v253
    v_rcp_f32 v254, v254
    v_rcp_f32 v255, v255
    v_pk_mul_f32 v[248:249], v[248:249], v[184:185]
    v_pk_mul_f32 v[250:251], v[250:251], v[186:187]
    v_pk_mul_f32 v[252:253], v[252:253], v[188:189]
    v_pk_mul_f32 v[254:255], v[254:255], v[190:191]
    v_pk_mul_f32 v[248:249], v[248:249], v[192:193]
    v_pk_mul_f32 v[250:251], v[250:251], v[194:195]
    v_pk_mul_f32 v[252:253], v[252:253], v[196:197]
    v_pk_mul_f32 v[254:255], v[254:255], v[198:199]
    v_cvt_pk_bf16_f32 v184, v248, v249
    v_cvt_pk_bf16_f32 v185, v250, v251
    v_cvt_pk_bf16_f32 v186, v252, v253
    v_cvt_pk_bf16_f32 v187, v254, v255
    buffer_store_dwordx4 v[184:187], v2, s[24:27], s70 offen offset:1024 sc1
    buffer_load_dwordx4 v[36:39], v2, s[24:27], s10 offen offset:3072 sc1
    v_mov_b64 v[88:89], v[136:137]
    v_mov_b64 v[90:91], v[136:137]
    v_mov_b64 v[92:93], v[136:137]
    v_mov_b64 v[94:95], v[136:137]
    s_mov_b64 exec, s[74:75]
    buffer_load_dwordx4 v[88:91], v3, s[24:27], s11 offen offset:2048 sc1
    buffer_load_dwordx4 v[92:95], v3, s[24:27], s11 offen offset:2560 sc1
    s_mov_b64 exec, -1
    s_cmp_ge_u32 s71, 84
    s_cselect_b32 s70, s68, s70
    v_pk_mul_f32 v[240:241], v[200:201], v[200:201]
    v_pk_mul_f32 v[242:243], v[202:203], v[202:203]
    v_pk_mul_f32 v[244:245], v[204:205], v[204:205]
    v_pk_mul_f32 v[246:247], v[206:207], v[206:207]
    v_pk_fma_f32 v[240:241], v[240:241], s[72:73], v[4:5] op_sel_hi:[1,1,0]
    v_pk_fma_f32 v[242:243], v[242:243], s[72:73], v[4:5] op_sel_hi:[1,1,0]
    v_pk_fma_f32 v[244:245], v[244:245], s[72:73], v[4:5] op_sel_hi:[1,1,0]
    v_pk_fma_f32 v[246:247], v[246:247], s[72:73], v[4:5] op_sel_hi:[1,1,0]
    v_pk_mul_f32 v[240:241], v[240:241], v[200:201]
    v_pk_mul_f32 v[242:243], v[242:243], v[202:203]
    v_pk_mul_f32 v[244:245], v[244:245], v[204:205]
    v_pk_mul_f32 v[246:247], v[246:247], v[206:207]
    v_exp_f32 v240, v240
    v_exp_f32 v241, v241
    v_exp_f32 v242, v242
    v_exp_f32 v243, v243
    v_exp_f32 v244, v244
    v_exp_f32 v245, v245
    v_exp_f32 v246, v246
    v_exp_f32 v247, v247
    v_pk_fma_f32 v[240:241], v[240:241], v[0:1], v[0:1] op_sel_hi:[1,0,0]
    v_pk_fma_f32 v[242:243], v[242:243], v[0:1], v[0:1] op_sel_hi:[1,0,0]
    v_pk_fma_f32 v[244:245], v[244:245], v[0:1], v[0:1] op_sel_hi:[1,0,0]
    v_pk_fma_f32 v[246:247], v[246:247], v[0:1], v[0:1] op_sel_hi:[1,0,0]
    v_rcp_f32 v240, v240
    v_rcp_f32 v241, v241
    v_rcp_f32 v242, v242
    v_rcp_f32 v243, v243
    v_rcp_f32 v244, v244
    v_rcp_f32 v245, v245
    v_rcp_f32 v246, v246
    v_rcp_f32 v247, v247
    v_pk_mul_f32 v[240:241], v[240:241], v[200:201]
    v_pk_mul_f32 v[242:243], v[242:243], v[202:203]
    v_pk_mul_f32 v[244:245], v[244:245], v[204:205]
    v_pk_mul_f32 v[246:247], v[246:247], v[206:207]
    v_pk_mul_f32 v[240:241], v[240:241], v[208:209]
    v_pk_mul_f32 v[242:243], v[242:243], v[210:211]
    v_pk_mul_f32 v[244:245], v[244:245], v[212:213]
    v_pk_mul_f32 v[246:247], v[246:247], v[214:215]
    v_cvt_pk_bf16_f32 v200, v240, v241
    v_cvt_pk_bf16_f32 v201, v242, v243
    v_cvt_pk_bf16_f32 v202, v244, v245
    v_cvt_pk_bf16_f32 v203, v246, v247
    buffer_store_dwordx4 v[200:203], v2, s[24:27], s70 offen offset:2048 sc1
    v_mov_b64 v[96:97], v[136:137]
    v_mov_b64 v[98:99], v[136:137]
    v_mov_b64 v[100:101], v[136:137]
    v_mov_b64 v[102:103], v[136:137]
    s_mov_b64 exec, s[74:75]
    buffer_load_dwordx4 v[96:99], v3, s[24:27], s11 offen offset:3072 sc1
    buffer_load_dwordx4 v[100:103], v3, s[24:27], s11 offen offset:3584 sc1
    s_mov_b64 exec, -1
    s_add_u32 s34, s7, 1
    s_and_b32 s34, s34, 7
    s_xor_b32 s34, s34, s39
    s_lshl_b32 s34, s34, 10
    s_add_u32 s34, s34, s6
    buffer_load_dwordx4 v[164:167], v2, s[24:27], s34 offen sc1
    s_lshl_b32 s76, s39, 12
    s_add_u32 s76, s76, 122880
    s_add_u32 s77, s38, 0
    s_and_b32 s77, s77, 3
    s_lshl_b32 s77, s77, 10
    s_add_u32 s77, s77, s76
    v_add_u32 v4, s77, v2
    s_add_u32 s77, s38, 1
    s_and_b32 s77, s77, 3
    s_lshl_b32 s77, s77, 10
    s_add_u32 s77, s77, s76
    v_add_u32 v5, s77, v2
    s_add_u32 s77, s38, 2
    s_and_b32 s77, s77, 3
    s_lshl_b32 s77, s77, 10
    s_add_u32 s77, s77, s76
    v_add_u32 v0, s77, v2
    s_add_u32 s77, s38, 3
    s_and_b32 s77, s77, 3
    s_lshl_b32 s77, s77, 10
    s_add_u32 s77, s77, s76
    v_add_u32 v7, s77, v2
    s_setprio 0
    s_waitcnt vmcnt(27)
    v_mfma_f32_32x32x16_bf16 v[104:119], v[8:11], v[160:163], 0
    s_nop 7
    s_nop 3
    v_exp_f32 v104, v104
    v_exp_f32 v105, v105
    v_exp_f32 v106, v106
    v_cvt_pk_bf16_f32 v136, v104, v105
    v_exp_f32 v107, v107
    v_exp_f32 v108, v108
    v_cvt_pk_bf16_f32 v137, v106, v107
    v_exp_f32 v109, v109
    v_exp_f32 v110, v110
    s_waitcnt vmcnt(26)
    v_mfma_f32_32x32x16_bf16 v[120:135], v[12:15], v[160:163], 0
    v_cvt_pk_bf16_f32 v138, v108, v109
    v_exp_f32 v111, v111
    v_exp_f32 v112, v112
    v_cvt_pk_bf16_f32 v139, v110, v111
    v_exp_f32 v113, v113
    v_exp_f32 v114, v114
    v_exp_f32 v115, v115
    s_waitcnt vmcnt(24)
    v_mfma_f32_32x32x16_bf16 v[144:159], v[40:43], v[136:139], 0
    v_cvt_pk_bf16_f32 v140, v112, v113
    v_exp_f32 v116, v116
    v_cvt_pk_bf16_f32 v141, v114, v115
    v_exp_f32 v117, v117
    v_exp_f32 v118, v118
    v_cvt_pk_bf16_f32 v142, v116, v117
    v_exp_f32 v119, v119
    v_exp_f32 v120, v120
    s_setprio 2
    v_cvt_pk_bf16_f32 v143, v118, v119
    v_exp_f32 v121, v121
    v_exp_f32 v122, v122
    v_mfma_f32_32x32x16_bf16 v[144:159], v[44:47], v[140:143], v[144:159]
    v_cvt_pk_bf16_f32 v136, v120, v121
    v_exp_f32 v123, v123
    v_exp_f32 v124, v124
    v_cvt_pk_bf16_f32 v137, v122, v123
    v_exp_f32 v125, v125
    v_exp_f32 v126, v126
    s_waitcnt vmcnt(23)
    v_mfma_f32_32x32x16_bf16 v[104:119], v[16:19], v[160:163], 0
    v_cvt_pk_bf16_f32 v138, v124, v125
    v_exp_f32 v127, v127
    v_exp_f32 v128, v128
    v_cvt_pk_bf16_f32 v139, v126, v127
    v_exp_f32 v129, v129
    v_exp_f32 v130, v130
    v_exp_f32 v131, v131
    s_waitcnt vmcnt(21)
    v_mfma_f32_32x32x16_bf16 v[144:159], v[48:51], v[136:139], v[144:159]
    v_cvt_pk_bf16_f32 v140, v128, v129
    v_exp_f32 v132, v132
    v_cvt_pk_bf16_f32 v141, v130, v131
    v_exp_f32 v133, v133
    v_exp_f32 v134, v134
    v_cvt_pk_bf16_f32 v142, v132, v133
    v_exp_f32 v135, v135
    v_exp_f32 v104, v104
    v_cvt_pk_bf16_f32 v143, v134, v135
    v_exp_f32 v105, v105
    v_exp_f32 v106, v106
    v_mfma_f32_32x32x16_bf16 v[144:159], v[52:55], v[140:143], v[144:159]
    v_cvt_pk_bf16_f32 v136, v104, v105
    v_exp_f32 v107, v107
    v_exp_f32 v108, v108
    v_cvt_pk_bf16_f32 v137, v106, v107
    v_exp_f32 v109, v109
    v_exp_f32 v110, v110
    s_waitcnt vmcnt(20)
    v_mfma_f32_32x32x16_bf16 v[120:135], v[20:23], v[160:163], 0
    v_cvt_pk_bf16_f32 v138, v108, v109
    v_exp_f32 v111, v111
    v_exp_f32 v112, v112
    v_cvt_pk_bf16_f32 v139, v110, v111
    v_exp_f32 v113, v113
    v_exp_f32 v114, v114
    v_exp_f32 v115, v115
    s_waitcnt vmcnt(18)
    v_mfma_f32_32x32x16_bf16 v[144:159], v[56:59], v[136:139], v[144:159]
    v_cvt_pk_bf16_f32 v140, v112, v113
    v_exp_f32 v116, v116
    v_cvt_pk_bf16_f32 v141, v114, v115
    v_exp_f32 v117, v117
    v_exp_f32 v118, v118
    v_cvt_pk_bf16_f32 v142, v116, v117
    v_exp_f32 v119, v119
    v_exp_f32 v120, v120
    v_cvt_pk_bf16_f32 v143, v118, v119
    v_exp_f32 v121, v121
    v_exp_f32 v122, v122
    v_mfma_f32_32x32x16_bf16 v[144:159], v[60:63], v[140:143], v[144:159]
    v_cvt_pk_bf16_f32 v136, v120, v121
    v_exp_f32 v123, v123
    v_exp_f32 v124, v124
    v_cvt_pk_bf16_f32 v137, v122, v123
    v_exp_f32 v125, v125
    v_exp_f32 v126, v126
    s_waitcnt vmcnt(17)
    v_mfma_f32_32x32x16_bf16 v[104:119], v[24:27], v[160:163], 0
    v_cvt_pk_bf16_f32 v138, v124, v125
    v_exp_f32 v127, v127
    v_exp_f32 v128, v128
    v_cvt_pk_bf16_f32 v139, v126, v127
    v_exp_f32 v129, v129
    v_exp_f32 v130, v130
    v_exp_f32 v131, v131
    s_waitcnt vmcnt(15)
    v_mfma_f32_32x32x16_bf16 v[144:159], v[64:67], v[136:139], v[144:159]
    v_cvt_pk_bf16_f32 v140, v128, v129
    v_exp_f32 v132, v132
    v_cvt_pk_bf16_f32 v141, v130, v131
    v_exp_f32 v133, v133
    v_exp_f32 v134, v134
    v_cvt_pk_bf16_f32 v142, v132, v133
    v_exp_f32 v135, v135
    v_exp_f32 v104, v104
    v_cvt_pk_bf16_f32 v143, v134, v135
    v_exp_f32 v105, v105
    v_exp_f32 v106, v106
    v_mfma_f32_32x32x16_bf16 v[144:159], v[68:71], v[140:143], v[144:159]
    v_cvt_pk_bf16_f32 v136, v104, v105
    v_exp_f32 v107, v107
    v_exp_f32 v108, v108
    v_cvt_pk_bf16_f32 v137, v106, v107
    v_exp_f32 v109, v109
    v_exp_f32 v110, v110
    s_waitcnt vmcnt(14)
    v_mfma_f32_32x32x16_bf16 v[120:135], v[28:31], v[160:163], 0
    v_cvt_pk_bf16_f32 v138, v108, v109
    v_exp_f32 v111, v111
    v_exp_f32 v112, v112
    v_cvt_pk_bf16_f32 v139, v110, v111
    v_exp_f32 v113, v113
    v_exp_f32 v114, v114
    v_exp_f32 v115, v115
    s_waitcnt vmcnt(12)
    v_mfma_f32_32x32x16_bf16 v[144:159], v[72:75], v[136:139], v[144:159]
    v_cvt_pk_bf16_f32 v140, v112, v113
    v_exp_f32 v116, v116
    v_cvt_pk_bf16_f32 v141, v114, v115
    v_exp_f32 v117, v117
    v_exp_f32 v118, v118
    v_cvt_pk_bf16_f32 v142, v116, v117
    v_exp_f32 v119, v119
    v_exp_f32 v120, v120
    v_cvt_pk_bf16_f32 v143, v118, v119
    v_exp_f32 v121, v121
    v_exp_f32 v122, v122
    v_mfma_f32_32x32x16_bf16 v[144:159], v[76:79], v[140:143], v[144:159]
    v_cvt_pk_bf16_f32 v136, v120, v121
    v_exp_f32 v123, v123
    v_exp_f32 v124, v124
    v_cvt_pk_bf16_f32 v137, v122, v123
    v_exp_f32 v125, v125
    v_exp_f32 v126, v126
    s_waitcnt vmcnt(10)
    v_mfma_f32_32x32x16_bf16 v[104:119], v[32:35], v[160:163], 0
    v_cvt_pk_bf16_f32 v138, v124, v125
    v_exp_f32 v127, v127
    v_exp_f32 v128, v128
    v_cvt_pk_bf16_f32 v139, v126, v127
    v_exp_f32 v129, v129
    v_exp_f32 v130, v130
    v_exp_f32 v131, v131
    s_waitcnt vmcnt(8)
    v_mfma_f32_32x32x16_bf16 v[144:159], v[80:83], v[136:139], v[144:159]
    v_cvt_pk_bf16_f32 v140, v128, v129
    v_exp_f32 v132, v132
    v_cvt_pk_bf16_f32 v141, v130, v131
    v_exp_f32 v133, v133
    v_exp_f32 v134, v134
    v_cvt_pk_bf16_f32 v142, v132, v133
    v_exp_f32 v135, v135
    v_exp_f32 v104, v104
    v_cvt_pk_bf16_f32 v143, v134, v135
    v_exp_f32 v105, v105
    v_exp_f32 v106, v106
    v_mfma_f32_32x32x16_bf16 v[144:159], v[84:87], v[140:143], v[144:159]
    v_cvt_pk_bf16_f32 v136, v104, v105
    v_exp_f32 v107, v107
    v_exp_f32 v108, v108
    v_cvt_pk_bf16_f32 v137, v106, v107
    v_exp_f32 v109, v109
    v_exp_f32 v110, v110
    s_waitcnt vmcnt(6)
    v_mfma_f32_32x32x16_bf16 v[120:135], v[36:39], v[160:163], 0
    v_cvt_pk_bf16_f32 v138, v108, v109
    v_exp_f32 v111, v111
    v_exp_f32 v112, v112
    v_cvt_pk_bf16_f32 v139, v110, v111
    v_exp_f32 v113, v113
    v_exp_f32 v114, v114
    v_exp_f32 v115, v115
    s_waitcnt vmcnt(4)
    v_mfma_f32_32x32x16_bf16 v[144:159], v[88:91], v[136:139], v[144:159]
    v_cvt_pk_bf16_f32 v140, v112, v113
    v_exp_f32 v116, v116
    v_cvt_pk_bf16_f32 v141, v114, v115
    v_exp_f32 v117, v117
    v_exp_f32 v118, v118
    v_cvt_pk_bf16_f32 v142, v116, v117
    v_exp_f32 v119, v119
    v_exp_f32 v120, v120
    v_cvt_pk_bf16_f32 v143, v118, v119
    v_exp_f32 v121, v121
    v_exp_f32 v122, v122
    v_mfma_f32_32x32x16_bf16 v[144:159], v[92:95], v[140:143], v[144:159]
    v_cvt_pk_bf16_f32 v136, v120, v121
    v_exp_f32 v123, v123
    v_exp_f32 v124, v124
    v_cvt_pk_bf16_f32 v137, v122, v123
    v_exp_f32 v125, v125
    v_exp_f32 v126, v126
    v_cvt_pk_bf16_f32 v138, v124, v125
    v_and_b32 v253, 0x70, v2
    v_lshrrev_b32 v253, 2, v253
    v_add_u32 v253, 155616, v253
    ds_read_b32 v252, v253
    v_exp_f32 v127, v127
    v_exp_f32 v128, v128
    v_cvt_pk_bf16_f32 v139, v126, v127
    v_exp_f32 v129, v129
    v_exp_f32 v130, v130
    v_exp_f32 v131, v131
    s_waitcnt vmcnt(1)
    v_mfma_f32_32x32x16_bf16 v[144:159], v[96:99], v[136:139], v[144:159]
    v_cvt_pk_bf16_f32 v140, v128, v129
    v_exp_f32 v132, v132
    v_cvt_pk_bf16_f32 v141, v130, v131
    v_exp_f32 v133, v133
    v_exp_f32 v134, v134
    v_cvt_pk_bf16_f32 v142, v132, v133
    v_exp_f32 v135, v135
join_2:
    s_setprio 3
    v_cvt_pk_bf16_f32 v143, v134, v135
    s_waitcnt vmcnt(0)
    v_mfma_f32_32x32x16_bf16 v[104:119], v[8:11], v[164:167], 0
    v_mfma_f32_32x32x16_bf16 v[144:159], v[100:103], v[140:143], v[144:159]
    v_mov_b32 v255, s100
    s_mov_b64 exec, 1
    buffer_store_dword v255, off, s[24:27], s62 sc1
    buffer_store_dword v255, off, s[24:27], s28 sc1
    s_mov_b64 exec, -1
    s_add_u32 s34, s7, 2
    s_and_b32 s34, s34, 7
    s_xor_b32 s34, s34, s39
    s_lshl_b32 s34, s34, 10
    s_add_u32 s34, s34, s6
    buffer_load_dwordx4 v[160:163], v2, s[24:27], s34 offen sc1
    s_nop 1
    s_waitcnt lgkmcnt(0)
    v_cmp_eq_u32 vcc, -1, v252
    s_cbranch_vccnz retry_11
back_12:
    v_mov_b32 v153, 1
    ds_write_b128 v4, v[144:147] offset:0
    ds_write_b128 v4, v[148:151] offset:8192
    ds_write_b64 v4, v[152:153] offset:32768
    s_add_u32 m0, s58, 0
    s_add_u32 s59, s57, 0
    buffer_load_dwordx4 v1, s[40:43], s59 offen lds
    s_add_u32 m0, s58, 2048
    s_add_u32 s59, s57, 65536
    buffer_load_dwordx4 v1, s[40:43], s59 offen lds
    s_add_u32 m0, s58, 4096
    s_add_u32 s59, s57, 131072
    buffer_load_dwordx4 v1, s[40:43], s59 offen lds
    s_add_u32 m0, s58, 6144
    s_add_u32 s59, s57, 196608
    buffer_load_dwordx4 v1, s[40:43], s59 offen lds
    s_add_u32 m0, s58, 8192
    s_add_u32 s59, s57, 262144
    buffer_load_dwordx4 v1, s[40:43], s59 offen lds
    s_add_u32 m0, s58, 40960
    s_add_u32 s59, s57, 327680
    buffer_load_dwordx4 v1, s[40:43], s59 offen lds
    s_add_u32 m0, s58, 43008
    s_add_u32 s59, s57, 393216
    buffer_load_dwordx4 v1, s[40:43], s59 offen lds
    s_waitcnt lgkmcnt(0)
    s_setprio 0
    v_exp_f32 v104, v104
    v_exp_f32 v105, v105
    v_exp_f32 v106, v106
    v_cvt_pk_bf16_f32 v136, v104, v105
    v_exp_f32 v107, v107
    v_exp_f32 v108, v108
    v_cvt_pk_bf16_f32 v137, v106, v107
    v_exp_f32 v109, v109
    v_exp_f32 v110, v110
    v_mfma_f32_32x32x16_bf16 v[120:135], v[12:15], v[164:167], 0
    v_cvt_pk_bf16_f32 v138, v108, v109
    v_exp_f32 v111, v111
    v_exp_f32 v112, v112
    v_cvt_pk_bf16_f32 v139, v110, v111
    v_exp_f32 v113, v113
    v_exp_f32 v114, v114
    v_exp_f32 v115, v115
    v_mfma_f32_32x32x16_bf16 v[144:159], v[40:43], v[136:139], 0
    v_cvt_pk_bf16_f32 v140, v112, v113
    v_exp_f32 v116, v116
    v_cvt_pk_bf16_f32 v141, v114, v115
    v_exp_f32 v117, v117
    v_exp_f32 v118, v118
    v_cvt_pk_bf16_f32 v142, v116, v117
    v_exp_f32 v119, v119
    v_exp_f32 v120, v120
    s_setprio 2
    v_cvt_pk_bf16_f32 v143, v118, v119
    v_exp_f32 v121, v121
    v_exp_f32 v122, v122
    v_mfma_f32_32x32x16_bf16 v[144:159], v[44:47], v[140:143], v[144:159]
    v_cvt_pk_bf16_f32 v136, v120, v121
    v_exp_f32 v123, v123
    v_exp_f32 v124, v124
    v_cvt_pk_bf16_f32 v137, v122, v123
    v_exp_f32 v125, v125
    v_exp_f32 v126, v126
    v_mfma_f32_32x32x16_bf16 v[104:119], v[16:19], v[164:167], 0
    v_cvt_pk_bf16_f32 v138, v124, v125
    v_exp_f32 v127, v127
    v_exp_f32 v128, v128
    v_cvt_pk_bf16_f32 v139, v126, v127
    v_exp_f32 v129, v129
    v_exp_f32 v130, v130
    v_exp_f32 v131, v131
    v_mfma_f32_32x32x16_bf16 v[144:159], v[48:51], v[136:139], v[144:159]
    v_cvt_pk_bf16_f32 v140, v128, v129
    v_exp_f32 v132, v132
    v_cvt_pk_bf16_f32 v141, v130, v131
    v_exp_f32 v133, v133
    v_exp_f32 v134, v134
    v_cvt_pk_bf16_f32 v142, v132, v133
    v_exp_f32 v135, v135
    v_exp_f32 v104, v104
    v_cvt_pk_bf16_f32 v143, v134, v135
    v_exp_f32 v105, v105
    v_exp_f32 v106, v106
    v_mfma_f32_32x32x16_bf16 v[144:159], v[52:55], v[140:143], v[144:159]
    v_cvt_pk_bf16_f32 v136, v104, v105
    v_exp_f32 v107, v107
    v_exp_f32 v108, v108
    v_cvt_pk_bf16_f32 v137, v106, v107
    v_exp_f32 v109, v109
    v_exp_f32 v110, v110
    v_mfma_f32_32x32x16_bf16 v[120:135], v[20:23], v[164:167], 0
    v_cvt_pk_bf16_f32 v138, v108, v109
    v_exp_f32 v111, v111
    v_exp_f32 v112, v112
    v_cvt_pk_bf16_f32 v139, v110, v111
    v_exp_f32 v113, v113
    v_exp_f32 v114, v114
    v_exp_f32 v115, v115
    v_mfma_f32_32x32x16_bf16 v[144:159], v[56:59], v[136:139], v[144:159]
    v_cvt_pk_bf16_f32 v140, v112, v113
    v_exp_f32 v116, v116
    v_cvt_pk_bf16_f32 v141, v114, v115
    v_exp_f32 v117, v117
    v_exp_f32 v118, v118
    v_cvt_pk_bf16_f32 v142, v116, v117
    v_exp_f32 v119, v119
    v_exp_f32 v120, v120
    v_cvt_pk_bf16_f32 v143, v118, v119
    v_exp_f32 v121, v121
    v_exp_f32 v122, v122
    v_mfma_f32_32x32x16_bf16 v[144:159], v[60:63], v[140:143], v[144:159]
    v_cvt_pk_bf16_f32 v136, v120, v121
    v_exp_f32 v123, v123
    v_exp_f32 v124, v124
    v_cvt_pk_bf16_f32 v137, v122, v123
    v_exp_f32 v125, v125
    v_exp_f32 v126, v126
    v_mfma_f32_32x32x16_bf16 v[104:119], v[24:27], v[164:167], 0
    v_cvt_pk_bf16_f32 v138, v124, v125
    v_exp_f32 v127, v127
    v_exp_f32 v128, v128
    v_cvt_pk_bf16_f32 v139, v126, v127
    v_exp_f32 v129, v129
    v_exp_f32 v130, v130
    v_exp_f32 v131, v131
    v_mfma_f32_32x32x16_bf16 v[144:159], v[64:67], v[136:139], v[144:159]
    v_cvt_pk_bf16_f32 v140, v128, v129
    v_exp_f32 v132, v132
    v_cvt_pk_bf16_f32 v141, v130, v131
    v_exp_f32 v133, v133
    v_exp_f32 v134, v134
    v_cvt_pk_bf16_f32 v142, v132, v133
    v_exp_f32 v135, v135
    v_exp_f32 v104, v104
    v_cvt_pk_bf16_f32 v143, v134, v135
    v_exp_f32 v105, v105
    v_exp_f32 v106, v106
    v_mfma_f32_32x32x16_bf16 v[144:159], v[68:71], v[140:143], v[144:159]
    v_cvt_pk_bf16_f32 v136, v104, v105
    v_exp_f32 v107, v107
    v_exp_f32 v108, v108
    v_cvt_pk_bf16_f32 v137, v106, v107
    v_exp_f32 v109, v109
    v_exp_f32 v110, v110
    v_mfma_f32_32x32x16_bf16 v[120:135], v[28:31], v[164:167], 0
    v_cvt_pk_bf16_f32 v138, v108, v109
    v_exp_f32 v111, v111
    v_exp_f32 v112, v112
    v_cvt_pk_bf16_f32 v139, v110, v111
    v_exp_f32 v113, v113
    v_exp_f32 v114, v114
    v_exp_f32 v115, v115
    v_mfma_f32_32x32x16_bf16 v[144:159], v[72:75], v[136:139], v[144:159]
    v_cvt_pk_bf16_f32 v140, v112, v113
    v_exp_f32 v116, v116
    v_cvt_pk_bf16_f32 v141, v114, v115
    v_exp_f32 v117, v117
    v_exp_f32 v118, v118
    v_cvt_pk_bf16_f32 v142, v116, v117
    v_exp_f32 v119, v119
    v_exp_f32 v120, v120
    v_cvt_pk_bf16_f32 v143, v118, v119
    v_exp_f32 v121, v121
    v_exp_f32 v122, v122
    v_mfma_f32_32x32x16_bf16 v[144:159], v[76:79], v[140:143], v[144:159]
    v_cvt_pk_bf16_f32 v136, v120, v121
    v_exp_f32 v123, v123
    v_exp_f32 v124, v124
    v_cvt_pk_bf16_f32 v137, v122, v123
    v_exp_f32 v125, v125
    v_exp_f32 v126, v126
    v_mfma_f32_32x32x16_bf16 v[104:119], v[32:35], v[164:167], 0
    v_cvt_pk_bf16_f32 v138, v124, v125
    v_exp_f32 v127, v127
    v_exp_f32 v128, v128
    v_cvt_pk_bf16_f32 v139, v126, v127
    v_exp_f32 v129, v129
    v_exp_f32 v130, v130
    v_exp_f32 v131, v131
    v_mfma_f32_32x32x16_bf16 v[144:159], v[80:83], v[136:139], v[144:159]
    v_cvt_pk_bf16_f32 v140, v128, v129
    v_exp_f32 v132, v132
    v_cvt_pk_bf16_f32 v141, v130, v131
    v_exp_f32 v133, v133
    v_exp_f32 v134, v134
    v_cvt_pk_bf16_f32 v142, v132, v133
    v_exp_f32 v135, v135
    v_exp_f32 v104, v104
    v_cvt_pk_bf16_f32 v143, v134, v135
    v_exp_f32 v105, v105
    v_exp_f32 v106, v106
    v_mfma_f32_32x32x16_bf16 v[144:159], v[84:87], v[140:143], v[144:159]
    v_cvt_pk_bf16_f32 v136, v104, v105
    v_exp_f32 v107, v107
    v_exp_f32 v108, v108
    v_cvt_pk_bf16_f32 v137, v106, v107
    v_exp_f32 v109, v109
    v_exp_f32 v110, v110
    v_mfma_f32_32x32x16_bf16 v[120:135], v[36:39], v[164:167], 0
    v_cvt_pk_bf16_f32 v138, v108, v109
    v_exp_f32 v111, v111
    v_exp_f32 v112, v112
    v_cvt_pk_bf16_f32 v139, v110, v111
    v_exp_f32 v113, v113
    v_exp_f32 v114, v114
    v_exp_f32 v115, v115
    v_mfma_f32_32x32x16_bf16 v[144:159], v[88:91], v[136:139], v[144:159]
    v_cvt_pk_bf16_f32 v140, v112, v113
    v_exp_f32 v116, v116
    v_cvt_pk_bf16_f32 v141, v114, v115
    v_exp_f32 v117, v117
    v_exp_f32 v118, v118
    v_cvt_pk_bf16_f32 v142, v116, v117
    v_exp_f32 v119, v119
    v_exp_f32 v120, v120
    v_cvt_pk_bf16_f32 v143, v118, v119
    v_exp_f32 v121, v121
    v_exp_f32 v122, v122
    v_mfma_f32_32x32x16_bf16 v[144:159], v[92:95], v[140:143], v[144:159]
    v_cvt_pk_bf16_f32 v136, v120, v121
    v_exp_f32 v123, v123
    v_exp_f32 v124, v124
    v_cvt_pk_bf16_f32 v137, v122, v123
    v_exp_f32 v125, v125
    v_exp_f32 v126, v126
    v_cvt_pk_bf16_f32 v138, v124, v125
    v_exp_f32 v127, v127
    v_exp_f32 v128, v128
    v_cvt_pk_bf16_f32 v139, v126, v127
    v_exp_f32 v129, v129
    v_exp_f32 v130, v130
    v_exp_f32 v131, v131
    v_mfma_f32_32x32x16_bf16 v[144:159], v[96:99], v[136:139], v[144:159]
    v_cvt_pk_bf16_f32 v140, v128, v129
    v_exp_f32 v132, v132
    v_cvt_pk_bf16_f32 v141, v130, v131
    v_exp_f32 v133, v133
    v_exp_f32 v134, v134
    v_cvt_pk_bf16_f32 v142, v132, v133
    v_exp_f32 v135, v135
    s_setprio 3
    v_cvt_pk_bf16_f32 v143, v134, v135
    s_waitcnt vmcnt(0)
    v_mfma_f32_32x32x16_bf16 v[104:119], v[8:11], v[160:163], 0
    v_mfma_f32_32x32x16_bf16 v[144:159], v[100:103], v[140:143], v[144:159]
    s_add_u32 s34, s7, 3
    s_and_b32 s34, s34, 7
    s_xor_b32 s34, s34, s39
    s_lshl_b32 s34, s34, 10
    s_add_u32 s34, s34, s6
    buffer_load_dwordx4 v[164:167], v2, s[24:27], s34 offen sc1
    s_nop 5
    v_mov_b32 v153, 1
    ds_write_b128 v4, v[144:147] offset:16384
    ds_write_b128 v4, v[148:151] offset:24576
    ds_write_b64 v4, v[152:153] offset:32776
    ds_read_b64 v[152:153], v5 offset:32768
    ds_read_b128 v[144:147], v5 offset:0
    ds_read_b128 v[148:151], v5 offset:8192
    v_lshrrev_b32 v254, 2, v2
    s_lshl_b32 s61, s52, 8
    s_add_u32 s61, s61, 14749696
    v_lshrrev_b32 v200, 4, v2
    v_lshrrev_b32 v201, 5, v200
    v_bfe_u32 v202, v200, 2, 2
    v_lshl_add_u32 v201, v201, 2, v202
    v_lshlrev_b32 v201, 7, v201
    v_and_b32 v202, 1, v200
    v_lshl_add_u32 v201, v202, 6, v201
    v_and_b32 v202, 16, v200
    v_add_u32 v201, v202, v201
    v_and_b32 v202, 10, v200
    v_lshl_add_u32 v201, v202, 2, v201
    s_lshl_b32 s59, s54, 4
    v_xor_b32 v201, s59, v201
    s_mul_i32 s59, s54, 10240
    v_add_u32 v208, s59, v201
    v_xor_b32 v209, 32, v208
    v_add_u32 v210, 81920, v208
    v_add_u32 v211, 81920, v209
    s_add_u32 m0, s58, 45056
    s_add_u32 s59, s57, 458752
    buffer_load_dwordx4 v1, s[40:43], s59 offen lds
    s_add_u32 m0, s58, 47104
    s_add_u32 s59, s57, 524288
    buffer_load_dwordx4 v1, s[40:43], s59 offen lds
    s_add_u32 m0, s58, 49152
    s_add_u32 s59, s57, 589824
    buffer_load_dwordx4 v1, s[40:43], s59 offen lds
    s_add_u32 m0, s58, 81920
    s_add_u32 s59, s57, 655360
    buffer_load_dwordx4 v1, s[40:43], s59 offen lds
    s_add_u32 m0, s58, 83968
    s_add_u32 s59, s57, 720896
    buffer_load_dwordx4 v1, s[40:43], s59 offen lds
    s_add_u32 m0, s58, 86016
    s_add_u32 s59, s57, 786432
    buffer_load_dwordx4 v1, s[40:43], s59 offen lds
    s_add_u32 m0, s58, 88064
    s_add_u32 s59, s57, 851968
    buffer_load_dwordx4 v1, s[40:43], s59 offen lds
    s_add_u32 m0, s58, 90112
    s_add_u32 s59, s57, 917504
    buffer_load_dwordx4 v1, s[40:43], s59 offen lds
    s_waitcnt lgkmcnt(0)
    v_cmp_ne_u32 vcc, 1, v153
    s_cbranch_vccnz at_retry_13
at_back_14:
    s_setprio 0
    v_exp_f32 v104, v104
    v_exp_f32 v105, v105
    v_exp_f32 v106, v106
    v_cvt_pk_bf16_f32 v136, v104, v105
    v_exp_f32 v107, v107
    v_exp_f32 v108, v108
    v_cvt_pk_bf16_f32 v137, v106, v107
    v_exp_f32 v109, v109
    v_exp_f32 v110, v110
    v_mfma_f32_32x32x16_bf16 v[120:135], v[12:15], v[160:163], 0
    v_cvt_pk_bf16_f32 v138, v108, v109
    v_exp_f32 v111, v111
    v_exp_f32 v112, v112
    v_cvt_pk_bf16_f32 v139, v110, v111
    v_exp_f32 v113, v113
    v_exp_f32 v114, v114
    v_exp_f32 v115, v115
    v_mfma_f32_32x32x16_bf16 v[144:159], v[40:43], v[136:139], v[144:159]
    v_cvt_pk_bf16_f32 v140, v112, v113
    v_exp_f32 v116, v116
    v_cvt_pk_bf16_f32 v141, v114, v115
    v_exp_f32 v117, v117
    v_exp_f32 v118, v118
    v_cvt_pk_bf16_f32 v142, v116, v117
    v_exp_f32 v119, v119
    v_exp_f32 v120, v120
    s_setprio 2
    v_cvt_pk_bf16_f32 v143, v118, v119
    v_exp_f32 v121, v121
    v_exp_f32 v122, v122
    v_mfma_f32_32x32x16_bf16 v[144:159], v[44:47], v[140:143], v[144:159]
    v_cvt_pk_bf16_f32 v136, v120, v121
    v_exp_f32 v123, v123
    v_exp_f32 v124, v124
    v_cvt_pk_bf16_f32 v137, v122, v123
    v_exp_f32 v125, v125
    v_exp_f32 v126, v126
    v_mfma_f32_32x32x16_bf16 v[104:119], v[16:19], v[160:163], 0
    v_cvt_pk_bf16_f32 v138, v124, v125
    v_exp_f32 v127, v127
    v_exp_f32 v128, v128
    v_cvt_pk_bf16_f32 v139, v126, v127
    v_exp_f32 v129, v129
    v_exp_f32 v130, v130
    v_exp_f32 v131, v131
    v_mfma_f32_32x32x16_bf16 v[144:159], v[48:51], v[136:139], v[144:159]
    v_cvt_pk_bf16_f32 v140, v128, v129
    v_exp_f32 v132, v132
    v_cvt_pk_bf16_f32 v141, v130, v131
    v_exp_f32 v133, v133
    v_exp_f32 v134, v134
    v_cvt_pk_bf16_f32 v142, v132, v133
    v_exp_f32 v135, v135
    v_exp_f32 v104, v104
    v_cvt_pk_bf16_f32 v143, v134, v135
    v_exp_f32 v105, v105
    v_exp_f32 v106, v106
    v_mfma_f32_32x32x16_bf16 v[144:159], v[52:55], v[140:143], v[144:159]
    v_cvt_pk_bf16_f32 v136, v104, v105
    v_exp_f32 v107, v107
    v_exp_f32 v108, v108
    v_cvt_pk_bf16_f32 v137, v106, v107
    v_exp_f32 v109, v109
    v_exp_f32 v110, v110
    v_mfma_f32_32x32x16_bf16 v[120:135], v[20:23], v[160:163], 0
    v_cvt_pk_bf16_f32 v138, v108, v109
    v_exp_f32 v111, v111
    v_exp_f32 v112, v112
    v_cvt_pk_bf16_f32 v139, v110, v111
    v_exp_f32 v113, v113
    v_exp_f32 v114, v114
    v_exp_f32 v115, v115
    v_mfma_f32_32x32x16_bf16 v[144:159], v[56:59], v[136:139], v[144:159]
    v_cvt_pk_bf16_f32 v140, v112, v113
    v_exp_f32 v116, v116
    v_cvt_pk_bf16_f32 v141, v114, v115
    v_exp_f32 v117, v117
    v_exp_f32 v118, v118
    v_cvt_pk_bf16_f32 v142, v116, v117
    v_exp_f32 v119, v119
    v_exp_f32 v120, v120
    v_cvt_pk_bf16_f32 v143, v118, v119
    v_exp_f32 v121, v121
    v_exp_f32 v122, v122
    v_mfma_f32_32x32x16_bf16 v[144:159], v[60:63], v[140:143], v[144:159]
    v_cvt_pk_bf16_f32 v136, v120, v121
    v_exp_f32 v123, v123
    v_exp_f32 v124, v124
    v_cvt_pk_bf16_f32 v137, v122, v123
    v_exp_f32 v125, v125
    v_exp_f32 v126, v126
    v_mfma_f32_32x32x16_bf16 v[104:119], v[24:27], v[160:163], 0
    v_cvt_pk_bf16_f32 v138, v124, v125
    buffer_load_dword v255, v254, s[24:27], s61 offen sc1
    v_exp_f32 v127, v127
    v_exp_f32 v128, v128
    v_cvt_pk_bf16_f32 v139, v126, v127
    v_exp_f32 v129, v129
    v_exp_f32 v130, v130
    v_exp_f32 v131, v131
    v_mfma_f32_32x32x16_bf16 v[144:159], v[64:67], v[136:139], v[144:159]
    v_cvt_pk_bf16_f32 v140, v128, v129
    v_exp_f32 v132, v132
    v_cvt_pk_bf16_f32 v141, v130, v131
    v_exp_f32 v133, v133
    v_exp_f32 v134, v134
    v_cvt_pk_bf16_f32 v142, v132, v133
    v_exp_f32 v135, v135
    v_exp_f32 v104, v104
    v_cvt_pk_bf16_f32 v143, v134, v135
    v_exp_f32 v105, v105
    v_exp_f32 v106, v106
    v_mfma_f32_32x32x16_bf16 v[144:159], v[68:71], v[140:143], v[144:159]
    v_cvt_pk_bf16_f32 v136, v104, v105
    v_exp_f32 v107, v107
    v_exp_f32 v108, v108
    v_cvt_pk_bf16_f32 v137, v106, v107
    v_exp_f32 v109, v109
    v_exp_f32 v110, v110
    v_mfma_f32_32x32x16_bf16 v[120:135], v[28:31], v[160:163], 0
    v_cvt_pk_bf16_f32 v138, v108, v109
    v_exp_f32 v111, v111
    v_exp_f32 v112, v112
    v_cvt_pk_bf16_f32 v139, v110, v111
    v_exp_f32 v113, v113
    v_exp_f32 v114, v114
    v_exp_f32 v115, v115
    v_mfma_f32_32x32x16_bf16 v[144:159], v[72:75], v[136:139], v[144:159]
    v_cvt_pk_bf16_f32 v140, v112, v113
    v_exp_f32 v116, v116
    v_cvt_pk_bf16_f32 v141, v114, v115
    v_exp_f32 v117, v117
    v_exp_f32 v118, v118
    v_cvt_pk_bf16_f32 v142, v116, v117
    v_exp_f32 v119, v119
    v_exp_f32 v120, v120
    v_cvt_pk_bf16_f32 v143, v118, v119
    v_exp_f32 v121, v121
    v_exp_f32 v122, v122
    v_mfma_f32_32x32x16_bf16 v[144:159], v[76:79], v[140:143], v[144:159]
    v_cvt_pk_bf16_f32 v136, v120, v121
    v_exp_f32 v123, v123
    v_exp_f32 v124, v124
    v_cvt_pk_bf16_f32 v137, v122, v123
    v_exp_f32 v125, v125
    v_exp_f32 v126, v126
    v_mfma_f32_32x32x16_bf16 v[104:119], v[32:35], v[160:163], 0
    v_cvt_pk_bf16_f32 v138, v124, v125
    v_exp_f32 v127, v127
    v_exp_f32 v128, v128
    v_cvt_pk_bf16_f32 v139, v126, v127
    v_exp_f32 v129, v129
    v_exp_f32 v130, v130
    v_exp_f32 v131, v131
    v_mfma_f32_32x32x16_bf16 v[144:159], v[80:83], v[136:139], v[144:159]
    v_cvt_pk_bf16_f32 v140, v128, v129
    v_exp_f32 v132, v132
    v_cvt_pk_bf16_f32 v141, v130, v131
    v_exp_f32 v133, v133
    v_exp_f32 v134, v134
    v_cvt_pk_bf16_f32 v142, v132, v133
    v_exp_f32 v135, v135
    v_exp_f32 v104, v104
    v_cvt_pk_bf16_f32 v143, v134, v135
    v_exp_f32 v105, v105
    v_exp_f32 v106, v106
    v_mfma_f32_32x32x16_bf16 v[144:159], v[84:87], v[140:143], v[144:159]
    v_cvt_pk_bf16_f32 v136, v104, v105
    v_exp_f32 v107, v107
    v_exp_f32 v108, v108
    v_cvt_pk_bf16_f32 v137, v106, v107
    v_exp_f32 v109, v109
    v_exp_f32 v110, v110
    v_mfma_f32_32x32x16_bf16 v[120:135], v[36:39], v[160:163], 0
    v_cvt_pk_bf16_f32 v138, v108, v109
    v_exp_f32 v111, v111
    v_exp_f32 v112, v112
    v_cvt_pk_bf16_f32 v139, v110, v111
    v_exp_f32 v113, v113
    v_exp_f32 v114, v114
    v_exp_f32 v115, v115
    v_mfma_f32_32x32x16_bf16 v[144:159], v[88:91], v[136:139], v[144:159]
    v_cvt_pk_bf16_f32 v140, v112, v113
    v_exp_f32 v116, v116
    v_cvt_pk_bf16_f32 v141, v114, v115
    v_exp_f32 v117, v117
    v_exp_f32 v118, v118
    v_cvt_pk_bf16_f32 v142, v116, v117
    v_exp_f32 v119, v119
    v_exp_f32 v120, v120
    v_cvt_pk_bf16_f32 v143, v118, v119
    v_exp_f32 v121, v121
    v_exp_f32 v122, v122
    v_mfma_f32_32x32x16_bf16 v[144:159], v[92:95], v[140:143], v[144:159]
    v_cvt_pk_bf16_f32 v136, v120, v121
    v_exp_f32 v123, v123
    v_exp_f32 v124, v124
    v_cvt_pk_bf16_f32 v137, v122, v123
    v_exp_f32 v125, v125
    v_exp_f32 v126, v126
    v_cvt_pk_bf16_f32 v138, v124, v125
    v_exp_f32 v127, v127
    v_exp_f32 v128, v128
    v_cvt_pk_bf16_f32 v139, v126, v127
    v_exp_f32 v129, v129
    v_exp_f32 v130, v130
    v_exp_f32 v131, v131
    v_mfma_f32_32x32x16_bf16 v[144:159], v[96:99], v[136:139], v[144:159]
    v_cvt_pk_bf16_f32 v140, v128, v129
    v_exp_f32 v132, v132
    v_cvt_pk_bf16_f32 v141, v130, v131
    v_exp_f32 v133, v133
    v_exp_f32 v134, v134
    v_cvt_pk_bf16_f32 v142, v132, v133
    v_exp_f32 v135, v135
    s_setprio 3
    v_cvt_pk_bf16_f32 v143, v134, v135
    s_waitcnt vmcnt(1)
    v_mfma_f32_32x32x16_bf16 v[104:119], v[8:11], v[164:167], 0
    v_mfma_f32_32x32x16_bf16 v[144:159], v[100:103], v[140:143], v[144:159]
    s_add_u32 s34, s7, 4
    s_and_b32 s34, s34, 7
    s_xor_b32 s34, s34, s39
    s_lshl_b32 s34, s34, 10
    s_add_u32 s34, s34, s6
    buffer_load_dwordx4 v[160:163], v2, s[24:27], s34 offen sc1
    v_xor_b32 v253, 4096, v4
    ds_read_b32 v253, v253 offset:32780
    s_nop 3
    v_mov_b32 v153, 2
    ds_write_b128 v5, v[144:147] offset:0
    ds_write_b128 v5, v[148:151] offset:8192
    ds_write_b64 v5, v[152:153] offset:32768
    ds_read_b64 v[152:153], v5 offset:32776
    ds_read_b128 v[144:147], v5 offset:16384
    ds_read_b128 v[148:151], v5 offset:24576
    s_waitcnt vmcnt(1)
    v_cmp_ne_u32 vcc, s100, v255
    s_cbranch_vccnz retry_15
back_16:
    s_add_u32 s59, s56, 0
    buffer_load_dwordx4 v[212:215], v2, s[24:27], s59 offen sc1
    s_add_u32 s59, s56, 4096
    buffer_load_dwordx4 v[216:219], v2, s[24:27], s59 offen sc1
    s_add_u32 s59, s56, 8192
    buffer_load_dwordx4 v[220:223], v2, s[24:27], s59 offen sc1
    s_add_u32 s59, s56, 12288
    buffer_load_dwordx4 v[224:227], v2, s[24:27], s59 offen sc1
    s_add_u32 s59, s56, 16384
    buffer_load_dwordx4 v[228:231], v2, s[24:27], s59 offen sc1
    s_add_u32 s59, s56, 20480
    buffer_load_dwordx4 v[232:235], v2, s[24:27], s59 offen sc1
    s_add_u32 s59, s56, 24576
    buffer_load_dwordx4 v[236:239], v2, s[24:27], s59 offen sc1
    s_add_u32 s59, s56, 28672
    buffer_load_dwordx4 v[240:243], v2, s[24:27], s59 offen sc1
    s_add_u32 s59, s56, 32768
    buffer_load_dwordx4 v[244:247], v2, s[24:27], s59 offen sc1
    s_add_u32 s59, s56, 36864
    buffer_load_dwordx4 v[248:251], v2, s[24:27], s59 offen sc1
    s_waitcnt lgkmcnt(0)
    v_cmp_ne_u32 vcc, 1, v153
    s_cbranch_vccnz at_retry_17
at_back_18:
    v_cmp_gt_u32 vcc, 1, v253
    s_cbranch_vccnz mt_retry_19
mt_back_20:
    ds_read_b64_tr_b16 v[200:201], v208 offset:0
    ds_read_b64_tr_b16 v[202:203], v208 offset:1024
    s_setprio 0
    v_exp_f32 v104, v104
    v_exp_f32 v105, v105
    v_exp_f32 v106, v106
    s_waitcnt vmcnt(9) lgkmcnt(0)
    v_mfma_f32_32x32x16_bf16 v[168:183], v[200:203], v[212:215], 0
    ds_read_b64_tr_b16 v[204:205], v209 offset:0
    ds_read_b64_tr_b16 v[206:207], v209 offset:1024
    v_cvt_pk_bf16_f32 v136, v104, v105
    v_exp_f32 v107, v107
    v_exp_f32 v108, v108
    v_cvt_pk_bf16_f32 v137, v106, v107
    v_exp_f32 v109, v109
    v_exp_f32 v110, v110
    v_mfma_f32_32x32x16_bf16 v[120:135], v[12:15], v[164:167], 0
    v_cvt_pk_bf16_f32 v138, v108, v109
    v_exp_f32 v111, v111
    v_exp_f32 v112, v112
    v_cvt_pk_bf16_f32 v139, v110, v111
    v_exp_f32 v113, v113
    v_exp_f32 v114, v114
    v_exp_f32 v115, v115
    v_mfma_f32_32x32x16_bf16 v[144:159], v[40:43], v[136:139], v[144:159]
    v_cvt_pk_bf16_f32 v140, v112, v113
    v_exp_f32 v116, v116
    v_cvt_pk_bf16_f32 v141, v114, v115
    v_exp_f32 v117, v117
    s_waitcnt lgkmcnt(0)
    v_mfma_f32_32x32x16_bf16 v[184:199], v[204:207], v[212:215], 0
    ds_read_b64_tr_b16 v[200:201], v208 offset:2048
    ds_read_b64_tr_b16 v[202:203], v208 offset:3072
    v_exp_f32 v118, v118
    v_cvt_pk_bf16_f32 v142, v116, v117
    v_exp_f32 v119, v119
    v_exp_f32 v120, v120
    s_setprio 2
    v_cvt_pk_bf16_f32 v143, v118, v119
    v_exp_f32 v121, v121
    v_exp_f32 v122, v122
    v_mfma_f32_32x32x16_bf16 v[144:159], v[44:47], v[140:143], v[144:159]
    v_cvt_pk_bf16_f32 v136, v120, v121
    v_exp_f32 v123, v123
    v_exp_f32 v124, v124
    v_cvt_pk_bf16_f32 v137, v122, v123
    v_exp_f32 v125, v125
    v_exp_f32 v126, v126
    v_mfma_f32_32x32x16_bf16 v[104:119], v[16:19], v[164:167], 0
    v_cvt_pk_bf16_f32 v138, v124, v125
    v_exp_f32 v127, v127
    v_exp_f32 v128, v128
    v_cvt_pk_bf16_f32 v139, v126, v127
    v_exp_f32 v129, v129
    v_exp_f32 v130, v130
    v_exp_f32 v131, v131
    v_mfma_f32_32x32x16_bf16 v[144:159], v[48:51], v[136:139], v[144:159]
    v_cvt_pk_bf16_f32 v140, v128, v129
    v_exp_f32 v132, v132
    v_cvt_pk_bf16_f32 v141, v130, v131
    v_exp_f32 v133, v133
    s_waitcnt vmcnt(8) lgkmcnt(0)
    v_mfma_f32_32x32x16_bf16 v[168:183], v[200:203], v[216:219], v[168:183]
    ds_read_b64_tr_b16 v[204:205], v209 offset:2048
    ds_read_b64_tr_b16 v[206:207], v209 offset:3072
    v_exp_f32 v134, v134
    v_cvt_pk_bf16_f32 v142, v132, v133
    v_exp_f32 v135, v135
    v_exp_f32 v104, v104
    v_cvt_pk_bf16_f32 v143, v134, v135
    v_exp_f32 v105, v105
    v_exp_f32 v106, v106
    v_mfma_f32_32x32x16_bf16 v[144:159], v[52:55], v[140:143], v[144:159]
    v_cvt_pk_bf16_f32 v136, v104, v105
    v_exp_f32 v107, v107
    v_exp_f32 v108, v108
    v_cvt_pk_bf16_f32 v137, v106, v107
    v_exp_f32 v109, v109
    v_exp_f32 v110, v110
    v_mfma_f32_32x32x16_bf16 v[120:135], v[20:23], v[164:167], 0
    v_cvt_pk_bf16_f32 v138, v108, v109
    v_exp_f32 v111, v111
    v_exp_f32 v112, v112
    v_cvt_pk_bf16_f32 v139, v110, v111
    v_exp_f32 v113, v113
    v_exp_f32 v114, v114
    v_exp_f32 v115, v115
    v_mfma_f32_32x32x16_bf16 v[144:159], v[56:59], v[136:139], v[144:159]
    v_cvt_pk_bf16_f32 v140, v112, v113
    v_exp_f32 v116, v116
    v_cvt_pk_bf16_f32 v141, v114, v115
    v_exp_f32 v117, v117
    s_waitcnt lgkmcnt(0)
    v_mfma_f32_32x32x16_bf16 v[184:199], v[204:207], v[216:219], v[184:199]
    ds_read_b64_tr_b16 v[200:201], v208 offset:4096
    ds_read_b64_tr_b16 v[202:203], v208 offset:5120
    v_exp_f32 v118, v118
    v_cvt_pk_bf16_f32 v142, v116, v117
    v_exp_f32 v119, v119
    v_exp_f32 v120, v120
    v_cvt_pk_bf16_f32 v143, v118, v119
    v_exp_f32 v121, v121
    v_exp_f32 v122, v122
    v_mfma_f32_32x32x16_bf16 v[144:159], v[60:63], v[140:143], v[144:159]
    v_cvt_pk_bf16_f32 v136, v120, v121
    v_exp_f32 v123, v123
    v_exp_f32 v124, v124
    v_cvt_pk_bf16_f32 v137, v122, v123
    v_exp_f32 v125, v125
    v_exp_f32 v126, v126
    v_mfma_f32_32x32x16_bf16 v[104:119], v[24:27], v[164:167], 0
    v_cvt_pk_bf16_f32 v138, v124, v125
    v_exp_f32 v127, v127
    v_exp_f32 v128, v128
    v_cvt_pk_bf16_f32 v139, v126, v127
    v_exp_f32 v129, v129
    v_exp_f32 v130, v130
    v_exp_f32 v131, v131
    v_mfma_f32_32x32x16_bf16 v[144:159], v[64:67], v[136:139], v[144:159]
    v_cvt_pk_bf16_f32 v140, v128, v129
    v_exp_f32 v132, v132
    v_cvt_pk_bf16_f32 v141, v130, v131
    v_exp_f32 v133, v133
    s_waitcnt vmcnt(7) lgkmcnt(0)
    v_mfma_f32_32x32x16_bf16 v[168:183], v[200:203], v[220:223], v[168:183]
    ds_read_b64_tr_b16 v[204:205], v209 offset:4096
    ds_read_b64_tr_b16 v[206:207], v209 offset:5120
    v_exp_f32 v134, v134
    v_cvt_pk_bf16_f32 v142, v132, v133
    v_exp_f32 v135, v135
    v_exp_f32 v104, v104
    v_cvt_pk_bf16_f32 v143, v134, v135
    v_exp_f32 v105, v105
    v_exp_f32 v106, v106
    v_mfma_f32_32x32x16_bf16 v[144:159], v[68:71], v[140:143], v[144:159]
    v_cvt_pk_bf16_f32 v136, v104, v105
    v_exp_f32 v107, v107
    v_exp_f32 v108, v108
    v_cvt_pk_bf16_f32 v137, v106, v107
    v_exp_f32 v109, v109
    v_exp_f32 v110, v110
    v_mfma_f32_32x32x16_bf16 v[120:135], v[28:31], v[164:167], 0
    v_cvt_pk_bf16_f32 v138, v108, v109
    v_exp_f32 v111, v111
    v_exp_f32 v112, v112
    v_cvt_pk_bf16_f32 v139, v110, v111
    v_exp_f32 v113, v113
    v_exp_f32 v114, v114
    v_exp_f32 v115, v115
    v_mfma_f32_32x32x16_bf16 v[144:159], v[72:75], v[136:139], v[144:159]
    v_cvt_pk_bf16_f32 v140, v112, v113
    v_exp_f32 v116, v116
    v_cvt_pk_bf16_f32 v141, v114, v115
    v_exp_f32 v117, v117
    s_waitcnt lgkmcnt(0)
    v_mfma_f32_32x32x16_bf16 v[184:199], v[204:207], v[220:223], v[184:199]
    ds_read_b64_tr_b16 v[200:201], v208 offset:6144
    ds_read_b64_tr_b16 v[202:203], v208 offset:7168
    v_exp_f32 v118, v118
    v_cvt_pk_bf16_f32 v142, v116, v117
    v_exp_f32 v119, v119
    v_exp_f32 v120, v120
    v_cvt_pk_bf16_f32 v143, v118, v119
    v_exp_f32 v121, v121
    v_exp_f32 v122, v122
    v_mfma_f32_32x32x16_bf16 v[144:159], v[76:79], v[140:143], v[144:159]
    v_cvt_pk_bf16_f32 v136, v120, v121
    v_exp_f32 v123, v123
    v_exp_f32 v124, v124
    v_cvt_pk_bf16_f32 v137, v122, v123
    v_exp_f32 v125, v125
    v_exp_f32 v126, v126
    v_mfma_f32_32x32x16_bf16 v[104:119], v[32:35], v[164:167], 0
    v_cvt_pk_bf16_f32 v138, v124, v125
    v_exp_f32 v127, v127
    v_exp_f32 v128, v128
    v_cvt_pk_bf16_f32 v139, v126, v127
    v_exp_f32 v129, v129
    v_exp_f32 v130, v130
    v_exp_f32 v131, v131
    v_mfma_f32_32x32x16_bf16 v[144:159], v[80:83], v[136:139], v[144:159]
    v_cvt_pk_bf16_f32 v140, v128, v129
    v_exp_f32 v132, v132
    v_cvt_pk_bf16_f32 v141, v130, v131
    v_exp_f32 v133, v133
    s_waitcnt vmcnt(6) lgkmcnt(0)
    v_mfma_f32_32x32x16_bf16 v[168:183], v[200:203], v[224:227], v[168:183]
    ds_read_b64_tr_b16 v[204:205], v209 offset:6144
    ds_read_b64_tr_b16 v[206:207], v209 offset:7168
    v_exp_f32 v134, v134
    v_cvt_pk_bf16_f32 v142, v132, v133
    v_exp_f32 v135, v135
    v_exp_f32 v104, v104
    v_cvt_pk_bf16_f32 v143, v134, v135
    v_exp_f32 v105, v105
    v_exp_f32 v106, v106
    v_mfma_f32_32x32x16_bf16 v[144:159], v[84:87], v[140:143], v[144:159]
    v_cvt_pk_bf16_f32 v136, v104, v105
    v_exp_f32 v107, v107
    v_exp_f32 v108, v108
    v_cvt_pk_bf16_f32 v137, v106, v107
    v_exp_f32 v109, v109
    v_exp_f32 v110, v110
    v_mfma_f32_32x32x16_bf16 v[120:135], v[36:39], v[164:167], 0
    v_cvt_pk_bf16_f32 v138, v108, v109
    v_exp_f32 v111, v111
    v_exp_f32 v112, v112
    v_cvt_pk_bf16_f32 v139, v110, v111
    v_exp_f32 v113, v113
    v_exp_f32 v114, v114
    v_exp_f32 v115, v115
    v_mfma_f32_32x32x16_bf16 v[144:159], v[88:91], v[136:139], v[144:159]
    v_cvt_pk_bf16_f32 v140, v112, v113
    v_exp_f32 v116, v116
    v_cvt_pk_bf16_f32 v141, v114, v115
    v_exp_f32 v117, v117
    s_waitcnt lgkmcnt(0)
    v_mfma_f32_32x32x16_bf16 v[184:199], v[204:207], v[224:227], v[184:199]
    ds_read_b64_tr_b16 v[200:201], v208 offset:8192
    ds_read_b64_tr_b16 v[202:203], v208 offset:9216
    v_exp_f32 v118, v118
    v_cvt_pk_bf16_f32 v142, v116, v117
    v_exp_f32 v119, v119
    v_exp_f32 v120, v120
    v_cvt_pk_bf16_f32 v143, v118, v119
    v_exp_f32 v121, v121
    v_exp_f32 v122, v122
    v_mfma_f32_32x32x16_bf16 v[144:159], v[92:95], v[140:143], v[144:159]
    v_cvt_pk_bf16_f32 v136, v120, v121
    v_exp_f32 v123, v123
    v_exp_f32 v124, v124
    v_cvt_pk_bf16_f32 v137, v122, v123
    v_exp_f32 v125, v125
    v_exp_f32 v126, v126
    s_waitcnt vmcnt(5) lgkmcnt(0)
    v_mfma_f32_32x32x16_bf16 v[168:183], v[200:203], v[228:231], v[168:183]
    ds_read_b64_tr_b16 v[204:205], v209 offset:8192
    ds_read_b64_tr_b16 v[206:207], v209 offset:9216
    v_cvt_pk_bf16_f32 v138, v124, v125
    v_exp_f32 v127, v127
    v_exp_f32 v128, v128
    v_cvt_pk_bf16_f32 v139, v126, v127
    v_exp_f32 v129, v129
    v_exp_f32 v130, v130
    v_exp_f32 v131, v131
    v_mfma_f32_32x32x16_bf16 v[144:159], v[96:99], v[136:139], v[144:159]
    v_cvt_pk_bf16_f32 v140, v128, v129
    v_exp_f32 v132, v132
    v_cvt_pk_bf16_f32 v141, v130, v131
    v_exp_f32 v133, v133
    s_waitcnt lgkmcnt(0)
    v_mfma_f32_32x32x16_bf16 v[184:199], v[204:207], v[228:231], v[184:199]
    v_exp_f32 v134, v134
    v_cvt_pk_bf16_f32 v142, v132, v133
    v_exp_f32 v135, v135
    s_setprio 3
    v_cvt_pk_bf16_f32 v143, v134, v135
    s_nop 0
    v_mfma_f32_32x32x16_bf16 v[104:119], v[8:11], v[160:163], 0
    v_mfma_f32_32x32x16_bf16 v[144:159], v[100:103], v[140:143], v[144:159]
    s_add_u32 s34, s7, 5
    s_and_b32 s34, s34, 7
    s_xor_b32 s34, s34, s39
    s_lshl_b32 s34, s34, 10
    s_add_u32 s34, s34, s6
    buffer_load_dwordx4 v[164:167], v2, s[24:27], s34 offen sc1
    v_xor_b32 v253, 4096, v5
    ds_read_b32 v253, v253 offset:32772
    s_nop 3
    v_mov_b32 v153, 2
    ds_write_b128 v5, v[144:147] offset:16384
    ds_write_b128 v5, v[148:151] offset:24576
    ds_write_b64 v5, v[152:153] offset:32776
    ds_read_b64 v[152:153], v0 offset:32768
    ds_read_b128 v[144:147], v0 offset:0
    ds_read_b128 v[148:151], v0 offset:8192
    s_add_u32 s59, s56, 40960
    buffer_load_dwordx4 v[212:215], v2, s[24:27], s59 offen sc1
    s_add_u32 s59, s56, 45056
    buffer_load_dwordx4 v[216:219], v2, s[24:27], s59 offen sc1
    s_add_u32 s59, s56, 49152
    buffer_load_dwordx4 v[220:223], v2, s[24:27], s59 offen sc1
    s_add_u32 s59, s56, 53248
    buffer_load_dwordx4 v[224:227], v2, s[24:27], s59 offen sc1
    s_add_u32 s59, s56, 57344
    buffer_load_dwordx4 v[228:231], v2, s[24:27], s59 offen sc1
    s_waitcnt lgkmcnt(0)
    v_cmp_ne_u32 vcc, 2, v153
    s_cbranch_vccnz at_retry_21
at_back_22:
    v_cmp_gt_u32 vcc, 2, v253
    s_cbranch_vccnz mt_retry_23
mt_back_24:
    ds_read_b64_tr_b16 v[200:201], v208 offset:40960
    ds_read_b64_tr_b16 v[202:203], v208 offset:41984
    s_setprio 0
    v_exp_f32 v104, v104
    v_exp_f32 v105, v105
    v_exp_f32 v106, v106
    s_waitcnt vmcnt(10) lgkmcnt(0)
    v_mfma_f32_32x32x16_bf16 v[168:183], v[200:203], v[232:235], v[168:183]
    ds_read_b64_tr_b16 v[204:205], v209 offset:40960
    ds_read_b64_tr_b16 v[206:207], v209 offset:41984
    v_cvt_pk_bf16_f32 v136, v104, v105
    v_exp_f32 v107, v107
    v_exp_f32 v108, v108
    v_cvt_pk_bf16_f32 v137, v106, v107
    v_exp_f32 v109, v109
    v_exp_f32 v110, v110
    v_mfma_f32_32x32x16_bf16 v[120:135], v[12:15], v[160:163], 0
    v_cvt_pk_bf16_f32 v138, v108, v109
    v_exp_f32 v111, v111
    v_exp_f32 v112, v112
    v_cvt_pk_bf16_f32 v139, v110, v111
    v_exp_f32 v113, v113
    v_exp_f32 v114, v114
    v_exp_f32 v115, v115
    v_mfma_f32_32x32x16_bf16 v[144:159], v[40:43], v[136:139], v[144:159]
    v_cvt_pk_bf16_f32 v140, v112, v113
    v_exp_f32 v116, v116
    v_cvt_pk_bf16_f32 v141, v114, v115
    v_exp_f32 v117, v117
    s_waitcnt lgkmcnt(0)
    v_mfma_f32_32x32x16_bf16 v[184:199], v[204:207], v[232:235], v[184:199]
    ds_read_b64_tr_b16 v[200:201], v208 offset:43008
    ds_read_b64_tr_b16 v[202:203], v208 offset:44032
    v_exp_f32 v118, v118
    v_cvt_pk_bf16_f32 v142, v116, v117
    v_exp_f32 v119, v119
    v_exp_f32 v120, v120
    s_setprio 2
    v_cvt_pk_bf16_f32 v143, v118, v119
    v_exp_f32 v121, v121
    v_exp_f32 v122, v122
    v_mfma_f32_32x32x16_bf16 v[144:159], v[44:47], v[140:143], v[144:159]
    v_cvt_pk_bf16_f32 v136, v120, v121
    v_exp_f32 v123, v123
    v_exp_f32 v124, v124
    v_cvt_pk_bf16_f32 v137, v122, v123
    v_exp_f32 v125, v125
    v_exp_f32 v126, v126
    v_mfma_f32_32x32x16_bf16 v[104:119], v[16:19], v[160:163], 0
    v_cvt_pk_bf16_f32 v138, v124, v125
    v_exp_f32 v127, v127
    v_exp_f32 v128, v128
    v_cvt_pk_bf16_f32 v139, v126, v127
    v_exp_f32 v129, v129
    v_exp_f32 v130, v130
    v_exp_f32 v131, v131
    v_mfma_f32_32x32x16_bf16 v[144:159], v[48:51], v[136:139], v[144:159]
    v_cvt_pk_bf16_f32 v140, v128, v129
    v_exp_f32 v132, v132
    v_cvt_pk_bf16_f32 v141, v130, v131
    v_exp_f32 v133, v133
    s_waitcnt vmcnt(9) lgkmcnt(0)
    v_mfma_f32_32x32x16_bf16 v[168:183], v[200:203], v[236:239], v[168:183]
    ds_read_b64_tr_b16 v[204:205], v209 offset:43008
    ds_read_b64_tr_b16 v[206:207], v209 offset:44032
    v_exp_f32 v134, v134
    v_cvt_pk_bf16_f32 v142, v132, v133
    v_exp_f32 v135, v135
    v_exp_f32 v104, v104
    v_cvt_pk_bf16_f32 v143, v134, v135
    v_exp_f32 v105, v105
    v_exp_f32 v106, v106
    v_mfma_f32_32x32x16_bf16 v[144:159], v[52:55], v[140:143], v[144:159]
    v_cvt_pk_bf16_f32 v136, v104, v105
    v_exp_f32 v107, v107
    v_exp_f32 v108, v108
    v_cvt_pk_bf16_f32 v137, v106, v107
    v_exp_f32 v109, v109
    v_exp_f32 v110, v110
    v_mfma_f32_32x32x16_bf16 v[120:135], v[20:23], v[160:163], 0
    v_cvt_pk_bf16_f32 v138, v108, v109
    v_exp_f32 v111, v111
    v_exp_f32 v112, v112
    v_cvt_pk_bf16_f32 v139, v110, v111
    v_exp_f32 v113, v113
    v_exp_f32 v114, v114
    v_exp_f32 v115, v115
    v_mfma_f32_32x32x16_bf16 v[144:159], v[56:59], v[136:139], v[144:159]
    v_cvt_pk_bf16_f32 v140, v112, v113
    v_exp_f32 v116, v116
    v_cvt_pk_bf16_f32 v141, v114, v115
    v_exp_f32 v117, v117
    s_waitcnt lgkmcnt(0)
    v_mfma_f32_32x32x16_bf16 v[184:199], v[204:207], v[236:239], v[184:199]
    ds_read_b64_tr_b16 v[200:201], v208 offset:45056
    ds_read_b64_tr_b16 v[202:203], v208 offset:46080
    v_exp_f32 v118, v118
    v_cvt_pk_bf16_f32 v142, v116, v117
    v_exp_f32 v119, v119
    v_exp_f32 v120, v120
    v_cvt_pk_bf16_f32 v143, v118, v119
    v_exp_f32 v121, v121
    v_exp_f32 v122, v122
    v_mfma_f32_32x32x16_bf16 v[144:159], v[60:63], v[140:143], v[144:159]
    v_cvt_pk_bf16_f32 v136, v120, v121
    v_exp_f32 v123, v123
    v_exp_f32 v124, v124
    v_cvt_pk_bf16_f32 v137, v122, v123
    v_exp_f32 v125, v125
    v_exp_f32 v126, v126
    v_mfma_f32_32x32x16_bf16 v[104:119], v[24:27], v[160:163], 0
    v_cvt_pk_bf16_f32 v138, v124, v125
    v_exp_f32 v127, v127
    v_exp_f32 v128, v128
    v_cvt_pk_bf16_f32 v139, v126, v127
    v_exp_f32 v129, v129
    v_exp_f32 v130, v130
    v_exp_f32 v131, v131
    v_mfma_f32_32x32x16_bf16 v[144:159], v[64:67], v[136:139], v[144:159]
    v_cvt_pk_bf16_f32 v140, v128, v129
    v_exp_f32 v132, v132
    v_cvt_pk_bf16_f32 v141, v130, v131
    v_exp_f32 v133, v133
    s_waitcnt vmcnt(8) lgkmcnt(0)
    v_mfma_f32_32x32x16_bf16 v[168:183], v[200:203], v[240:243], v[168:183]
    ds_read_b64_tr_b16 v[204:205], v209 offset:45056
    ds_read_b64_tr_b16 v[206:207], v209 offset:46080
    v_exp_f32 v134, v134
    v_cvt_pk_bf16_f32 v142, v132, v133
    v_exp_f32 v135, v135
    v_exp_f32 v104, v104
    v_cvt_pk_bf16_f32 v143, v134, v135
    v_exp_f32 v105, v105
    v_exp_f32 v106, v106
    v_mfma_f32_32x32x16_bf16 v[144:159], v[68:71], v[140:143], v[144:159]
    v_cvt_pk_bf16_f32 v136, v104, v105
    v_exp_f32 v107, v107
    v_exp_f32 v108, v108
    v_cvt_pk_bf16_f32 v137, v106, v107
    v_exp_f32 v109, v109
    v_exp_f32 v110, v110
    v_mfma_f32_32x32x16_bf16 v[120:135], v[28:31], v[160:163], 0
    v_cvt_pk_bf16_f32 v138, v108, v109
    v_exp_f32 v111, v111
    v_exp_f32 v112, v112
    v_cvt_pk_bf16_f32 v139, v110, v111
    v_exp_f32 v113, v113
    v_exp_f32 v114, v114
    v_exp_f32 v115, v115
    v_mfma_f32_32x32x16_bf16 v[144:159], v[72:75], v[136:139], v[144:159]
    v_cvt_pk_bf16_f32 v140, v112, v113
    v_exp_f32 v116, v116
    v_cvt_pk_bf16_f32 v141, v114, v115
    v_exp_f32 v117, v117
    s_waitcnt lgkmcnt(0)
    v_mfma_f32_32x32x16_bf16 v[184:199], v[204:207], v[240:243], v[184:199]
    ds_read_b64_tr_b16 v[200:201], v208 offset:47104
    ds_read_b64_tr_b16 v[202:203], v208 offset:48128
    v_exp_f32 v118, v118
    v_cvt_pk_bf16_f32 v142, v116, v117
    v_exp_f32 v119, v119
    v_exp_f32 v120, v120
    v_cvt_pk_bf16_f32 v143, v118, v119
    v_exp_f32 v121, v121
    v_exp_f32 v122, v122
    v_mfma_f32_32x32x16_bf16 v[144:159], v[76:79], v[140:143], v[144:159]
    v_cvt_pk_bf16_f32 v136, v120, v121
    v_exp_f32 v123, v123
    v_exp_f32 v124, v124
    v_cvt_pk_bf16_f32 v137, v122, v123
    v_exp_f32 v125, v125
    v_exp_f32 v126, v126
    v_mfma_f32_32x32x16_bf16 v[104:119], v[32:35], v[160:163], 0
    v_cvt_pk_bf16_f32 v138, v124, v125
    v_exp_f32 v127, v127
    v_exp_f32 v128, v128
    v_cvt_pk_bf16_f32 v139, v126, v127
    v_exp_f32 v129, v129
    v_exp_f32 v130, v130
    v_exp_f32 v131, v131
    v_mfma_f32_32x32x16_bf16 v[144:159], v[80:83], v[136:139], v[144:159]
    v_cvt_pk_bf16_f32 v140, v128, v129
    v_exp_f32 v132, v132
    v_cvt_pk_bf16_f32 v141, v130, v131
    v_exp_f32 v133, v133
    s_waitcnt vmcnt(7) lgkmcnt(0)
    v_mfma_f32_32x32x16_bf16 v[168:183], v[200:203], v[244:247], v[168:183]
    ds_read_b64_tr_b16 v[204:205], v209 offset:47104
    ds_read_b64_tr_b16 v[206:207], v209 offset:48128
    v_exp_f32 v134, v134
    v_cvt_pk_bf16_f32 v142, v132, v133
    v_exp_f32 v135, v135
    v_exp_f32 v104, v104
    v_cvt_pk_bf16_f32 v143, v134, v135
    v_exp_f32 v105, v105
    v_exp_f32 v106, v106
    v_mfma_f32_32x32x16_bf16 v[144:159], v[84:87], v[140:143], v[144:159]
    v_cvt_pk_bf16_f32 v136, v104, v105
    v_exp_f32 v107, v107
    v_exp_f32 v108, v108
    v_cvt_pk_bf16_f32 v137, v106, v107
    v_exp_f32 v109, v109
    v_exp_f32 v110, v110
    v_mfma_f32_32x32x16_bf16 v[120:135], v[36:39], v[160:163], 0
    v_cvt_pk_bf16_f32 v138, v108, v109
    v_exp_f32 v111, v111
    v_exp_f32 v112, v112
    v_cvt_pk_bf16_f32 v139, v110, v111
    v_exp_f32 v113, v113
    v_exp_f32 v114, v114
    v_exp_f32 v115, v115
    v_mfma_f32_32x32x16_bf16 v[144:159], v[88:91], v[136:139], v[144:159]
    v_cvt_pk_bf16_f32 v140, v112, v113
    v_exp_f32 v116, v116
    v_cvt_pk_bf16_f32 v141, v114, v115
    v_exp_f32 v117, v117
    s_waitcnt lgkmcnt(0)
    v_mfma_f32_32x32x16_bf16 v[184:199], v[204:207], v[244:247], v[184:199]
    ds_read_b64_tr_b16 v[200:201], v208 offset:49152
    ds_read_b64_tr_b16 v[202:203], v208 offset:50176
    v_exp_f32 v118, v118
    v_cvt_pk_bf16_f32 v142, v116, v117
    v_exp_f32 v119, v119
    v_exp_f32 v120, v120
    v_cvt_pk_bf16_f32 v143, v118, v119
    v_exp_f32 v121, v121
    v_exp_f32 v122, v122
    v_mfma_f32_32x32x16_bf16 v[144:159], v[92:95], v[140:143], v[144:159]
    v_cvt_pk_bf16_f32 v136, v120, v121
    v_exp_f32 v123, v123
    v_exp_f32 v124, v124
    v_cvt_pk_bf16_f32 v137, v122, v123
    v_exp_f32 v125, v125
    v_exp_f32 v126, v126
    s_waitcnt vmcnt(6) lgkmcnt(0)
    v_mfma_f32_32x32x16_bf16 v[168:183], v[200:203], v[248:251], v[168:183]
    ds_read_b64_tr_b16 v[204:205], v209 offset:49152
    ds_read_b64_tr_b16 v[206:207], v209 offset:50176
    v_cvt_pk_bf16_f32 v138, v124, v125
    v_exp_f32 v127, v127
    v_exp_f32 v128, v128
    v_cvt_pk_bf16_f32 v139, v126, v127
    v_exp_f32 v129, v129
    v_exp_f32 v130, v130
    v_exp_f32 v131, v131
    v_mfma_f32_32x32x16_bf16 v[144:159], v[96:99], v[136:139], v[144:159]
    v_cvt_pk_bf16_f32 v140, v128, v129
    v_exp_f32 v132, v132
    v_cvt_pk_bf16_f32 v141, v130, v131
    v_exp_f32 v133, v133
    s_waitcnt lgkmcnt(0)
    v_mfma_f32_32x32x16_bf16 v[184:199], v[204:207], v[248:251], v[184:199]
    v_exp_f32 v134, v134
    v_cvt_pk_bf16_f32 v142, v132, v133
    v_exp_f32 v135, v135
    s_setprio 3
    v_cvt_pk_bf16_f32 v143, v134, v135
    s_waitcnt vmcnt(5)
    v_mfma_f32_32x32x16_bf16 v[104:119], v[8:11], v[164:167], 0
    v_mfma_f32_32x32x16_bf16 v[144:159], v[100:103], v[140:143], v[144:159]
    s_add_u32 s34, s7, 6
    s_and_b32 s34, s34, 7
    s_xor_b32 s34, s34, s39
    s_lshl_b32 s34, s34, 10
    s_add_u32 s34, s34, s6
    buffer_load_dwordx4 v[160:163], v2, s[24:27], s34 offen sc1
    v_xor_b32 v253, 4096, v5
    ds_read_b32 v253, v253 offset:32780
    s_nop 3
    v_mov_b32 v153, 3
    ds_write_b128 v0, v[144:147] offset:0
    ds_write_b128 v0, v[148:151] offset:8192
    ds_write_b64 v0, v[152:153] offset:32768
    ds_read_b64 v[152:153], v0 offset:32776
    ds_read_b128 v[144:147], v0 offset:16384
    ds_read_b128 v[148:151], v0 offset:24576
    s_add_u32 s59, s56, 61440
    buffer_load_dwordx4 v[232:235], v2, s[24:27], s59 offen sc1
    s_add_u32 s59, s56, 65536
    buffer_load_dwordx4 v[236:239], v2, s[24:27], s59 offen sc1
    s_add_u32 s59, s56, 69632
    buffer_load_dwordx4 v[240:243], v2, s[24:27], s59 offen sc1
    s_add_u32 s59, s56, 73728
    buffer_load_dwordx4 v[244:247], v2, s[24:27], s59 offen sc1
    s_add_u32 s59, s56, 77824
    buffer_load_dwordx4 v[248:251], v2, s[24:27], s59 offen sc1
    s_waitcnt lgkmcnt(0)
    v_cmp_ne_u32 vcc, 2, v153
    s_cbranch_vccnz at_retry_25
at_back_26:
    v_cmp_gt_u32 vcc, 2, v253
    s_cbranch_vccnz mt_retry_27
mt_back_28:
    ds_read_b64_tr_b16 v[200:201], v210 offset:0
    ds_read_b64_tr_b16 v[202:203], v210 offset:1024
    s_add_u32 m0, s58, 0
    s_add_u32 s59, s57, 983040
    buffer_load_dwordx4 v1, s[40:43], s59 offen lds
    s_add_u32 m0, s58, 2048
    s_add_u32 s59, s57, 1048576
    buffer_load_dwordx4 v1, s[40:43], s59 offen lds
    s_add_u32 m0, s58, 4096
    s_add_u32 s59, s57, 1114112
    buffer_load_dwordx4 v1, s[40:43], s59 offen lds
    s_add_u32 m0, s58, 6144
    s_add_u32 s59, s57, 1179648
    buffer_load_dwordx4 v1, s[40:43], s59 offen lds
    s_add_u32 m0, s58, 8192
    s_add_u32 s59, s57, 1245184
    buffer_load_dwordx4 v1, s[40:43], s59 offen lds
    s_setprio 0
    v_exp_f32 v104, v104
    v_exp_f32 v105, v105
    v_exp_f32 v106, v106
    s_waitcnt vmcnt(15) lgkmcnt(0)
    v_mfma_f32_32x32x16_bf16 v[168:183], v[200:203], v[212:215], v[168:183]
    ds_read_b64_tr_b16 v[204:205], v211 offset:0
    ds_read_b64_tr_b16 v[206:207], v211 offset:1024
    v_cvt_pk_bf16_f32 v136, v104, v105
    v_exp_f32 v107, v107
    v_exp_f32 v108, v108
    v_cvt_pk_bf16_f32 v137, v106, v107
    v_exp_f32 v109, v109
    v_exp_f32 v110, v110
    v_mfma_f32_32x32x16_bf16 v[120:135], v[12:15], v[164:167], 0
    v_cvt_pk_bf16_f32 v138, v108, v109
    v_exp_f32 v111, v111
    v_exp_f32 v112, v112
    v_cvt_pk_bf16_f32 v139, v110, v111
    v_exp_f32 v113, v113
    v_exp_f32 v114, v114
    v_exp_f32 v115, v115
    v_mfma_f32_32x32x16_bf16 v[144:159], v[40:43], v[136:139], v[144:159]
    v_cvt_pk_bf16_f32 v140, v112, v113
    v_exp_f32 v116, v116
    v_cvt_pk_bf16_f32 v141, v114, v115
    v_exp_f32 v117, v117
    s_waitcnt lgkmcnt(0)
    v_mfma_f32_32x32x16_bf16 v[184:199], v[204:207], v[212:215], v[184:199]
    ds_read_b64_tr_b16 v[200:201], v210 offset:2048
    ds_read_b64_tr_b16 v[202:203], v210 offset:3072
    v_exp_f32 v118, v118
    v_cvt_pk_bf16_f32 v142, v116, v117
    v_exp_f32 v119, v119
    v_exp_f32 v120, v120
    s_setprio 2
    v_cvt_pk_bf16_f32 v143, v118, v119
    v_exp_f32 v121, v121
    v_exp_f32 v122, v122
    v_mfma_f32_32x32x16_bf16 v[144:159], v[44:47], v[140:143], v[144:159]
    v_cvt_pk_bf16_f32 v136, v120, v121
    v_exp_f32 v123, v123
    v_exp_f32 v124, v124
    v_cvt_pk_bf16_f32 v137, v122, v123
    v_exp_f32 v125, v125
    v_exp_f32 v126, v126
    v_mfma_f32_32x32x16_bf16 v[104:119], v[16:19], v[164:167], 0
    v_cvt_pk_bf16_f32 v138, v124, v125
    v_exp_f32 v127, v127
    v_exp_f32 v128, v128
    v_cvt_pk_bf16_f32 v139, v126, v127
    v_exp_f32 v129, v129
    v_exp_f32 v130, v130
    v_exp_f32 v131, v131
    v_mfma_f32_32x32x16_bf16 v[144:159], v[48:51], v[136:139], v[144:159]
    v_cvt_pk_bf16_f32 v140, v128, v129
    v_exp_f32 v132, v132
    v_cvt_pk_bf16_f32 v141, v130, v131
    v_exp_f32 v133, v133
    s_waitcnt vmcnt(14) lgkmcnt(0)
    v_mfma_f32_32x32x16_bf16 v[168:183], v[200:203], v[216:219], v[168:183]
    ds_read_b64_tr_b16 v[204:205], v211 offset:2048
    ds_read_b64_tr_b16 v[206:207], v211 offset:3072
    v_exp_f32 v134, v134
    v_cvt_pk_bf16_f32 v142, v132, v133
    v_exp_f32 v135, v135
    v_exp_f32 v104, v104
    v_cvt_pk_bf16_f32 v143, v134, v135
    v_exp_f32 v105, v105
    v_exp_f32 v106, v106
    v_mfma_f32_32x32x16_bf16 v[144:159], v[52:55], v[140:143], v[144:159]
    v_cvt_pk_bf16_f32 v136, v104, v105
    v_exp_f32 v107, v107
    v_exp_f32 v108, v108
    v_cvt_pk_bf16_f32 v137, v106, v107
    v_exp_f32 v109, v109
    v_exp_f32 v110, v110
    v_mfma_f32_32x32x16_bf16 v[120:135], v[20:23], v[164:167], 0
    v_cvt_pk_bf16_f32 v138, v108, v109
    v_exp_f32 v111, v111
    v_exp_f32 v112, v112
    v_cvt_pk_bf16_f32 v139, v110, v111
    v_exp_f32 v113, v113
    v_exp_f32 v114, v114
    v_exp_f32 v115, v115
    v_mfma_f32_32x32x16_bf16 v[144:159], v[56:59], v[136:139], v[144:159]
    v_cvt_pk_bf16_f32 v140, v112, v113
    v_exp_f32 v116, v116
    v_cvt_pk_bf16_f32 v141, v114, v115
    v_exp_f32 v117, v117
    s_waitcnt lgkmcnt(0)
    v_mfma_f32_32x32x16_bf16 v[184:199], v[204:207], v[216:219], v[184:199]
    ds_read_b64_tr_b16 v[200:201], v210 offset:4096
    ds_read_b64_tr_b16 v[202:203], v210 offset:5120
    v_exp_f32 v118, v118
    v_cvt_pk_bf16_f32 v142, v116, v117
    v_exp_f32 v119, v119
    v_exp_f32 v120, v120
    v_cvt_pk_bf16_f32 v143, v118, v119
    v_exp_f32 v121, v121
    v_exp_f32 v122, v122
    v_mfma_f32_32x32x16_bf16 v[144:159], v[60:63], v[140:143], v[144:159]
    v_cvt_pk_bf16_f32 v136, v120, v121
    v_exp_f32 v123, v123
    v_exp_f32 v124, v124
    v_cvt_pk_bf16_f32 v137, v122, v123
    v_exp_f32 v125, v125
    v_exp_f32 v126, v126
    v_mfma_f32_32x32x16_bf16 v[104:119], v[24:27], v[164:167], 0
    v_cvt_pk_bf16_f32 v138, v124, v125
    v_exp_f32 v127, v127
    v_exp_f32 v128, v128
    v_cvt_pk_bf16_f32 v139, v126, v127
    v_exp_f32 v129, v129
    v_exp_f32 v130, v130
    v_exp_f32 v131, v131
    v_mfma_f32_32x32x16_bf16 v[144:159], v[64:67], v[136:139], v[144:159]
    v_cvt_pk_bf16_f32 v140, v128, v129
    v_exp_f32 v132, v132
    v_cvt_pk_bf16_f32 v141, v130, v131
    v_exp_f32 v133, v133
    s_waitcnt vmcnt(13) lgkmcnt(0)
    v_mfma_f32_32x32x16_bf16 v[168:183], v[200:203], v[220:223], v[168:183]
    ds_read_b64_tr_b16 v[204:205], v211 offset:4096
    ds_read_b64_tr_b16 v[206:207], v211 offset:5120
    v_exp_f32 v134, v134
    v_cvt_pk_bf16_f32 v142, v132, v133
    v_exp_f32 v135, v135
    v_exp_f32 v104, v104
    v_cvt_pk_bf16_f32 v143, v134, v135
    v_exp_f32 v105, v105
    v_exp_f32 v106, v106
    v_mfma_f32_32x32x16_bf16 v[144:159], v[68:71], v[140:143], v[144:159]
    v_cvt_pk_bf16_f32 v136, v104, v105
    v_exp_f32 v107, v107
    v_exp_f32 v108, v108
    v_cvt_pk_bf16_f32 v137, v106, v107
    v_exp_f32 v109, v109
    v_exp_f32 v110, v110
    v_mfma_f32_32x32x16_bf16 v[120:135], v[28:31], v[164:167], 0
    v_cvt_pk_bf16_f32 v138, v108, v109
    v_exp_f32 v111, v111
    v_exp_f32 v112, v112
    v_cvt_pk_bf16_f32 v139, v110, v111
    v_exp_f32 v113, v113
    v_exp_f32 v114, v114
    v_exp_f32 v115, v115
    v_mfma_f32_32x32x16_bf16 v[144:159], v[72:75], v[136:139], v[144:159]
    v_cvt_pk_bf16_f32 v140, v112, v113
    v_exp_f32 v116, v116
    v_cvt_pk_bf16_f32 v141, v114, v115
    v_exp_f32 v117, v117
    s_waitcnt lgkmcnt(0)
    v_mfma_f32_32x32x16_bf16 v[184:199], v[204:207], v[220:223], v[184:199]
    ds_read_b64_tr_b16 v[200:201], v210 offset:6144
    ds_read_b64_tr_b16 v[202:203], v210 offset:7168
    v_exp_f32 v118, v118
    v_cvt_pk_bf16_f32 v142, v116, v117
    v_exp_f32 v119, v119
    v_exp_f32 v120, v120
    v_cvt_pk_bf16_f32 v143, v118, v119
    v_exp_f32 v121, v121
    v_exp_f32 v122, v122
    v_mfma_f32_32x32x16_bf16 v[144:159], v[76:79], v[140:143], v[144:159]
    v_cvt_pk_bf16_f32 v136, v120, v121
    v_exp_f32 v123, v123
    v_exp_f32 v124, v124
    v_cvt_pk_bf16_f32 v137, v122, v123
    v_exp_f32 v125, v125
    v_exp_f32 v126, v126
    v_mfma_f32_32x32x16_bf16 v[104:119], v[32:35], v[164:167], 0
    v_cvt_pk_bf16_f32 v138, v124, v125
    v_exp_f32 v127, v127
    v_exp_f32 v128, v128
    v_cvt_pk_bf16_f32 v139, v126, v127
    v_exp_f32 v129, v129
    v_exp_f32 v130, v130
    v_exp_f32 v131, v131
    v_mfma_f32_32x32x16_bf16 v[144:159], v[80:83], v[136:139], v[144:159]
    v_cvt_pk_bf16_f32 v140, v128, v129
    v_exp_f32 v132, v132
    v_cvt_pk_bf16_f32 v141, v130, v131
    v_exp_f32 v133, v133
    s_waitcnt vmcnt(12) lgkmcnt(0)
    v_mfma_f32_32x32x16_bf16 v[168:183], v[200:203], v[224:227], v[168:183]
    ds_read_b64_tr_b16 v[204:205], v211 offset:6144
    ds_read_b64_tr_b16 v[206:207], v211 offset:7168
    v_exp_f32 v134, v134
    v_cvt_pk_bf16_f32 v142, v132, v133
    v_exp_f32 v135, v135
    v_exp_f32 v104, v104
    v_cvt_pk_bf16_f32 v143, v134, v135
    v_exp_f32 v105, v105
    v_exp_f32 v106, v106
    v_mfma_f32_32x32x16_bf16 v[144:159], v[84:87], v[140:143], v[144:159]
    v_cvt_pk_bf16_f32 v136, v104, v105
    v_exp_f32 v107, v107
    v_exp_f32 v108, v108
    v_cvt_pk_bf16_f32 v137, v106, v107
    v_exp_f32 v109, v109
    v_exp_f32 v110, v110
    v_mfma_f32_32x32x16_bf16 v[120:135], v[36:39], v[164:167], 0
    v_cvt_pk_bf16_f32 v138, v108, v109
    v_exp_f32 v111, v111
    v_exp_f32 v112, v112
    v_cvt_pk_bf16_f32 v139, v110, v111
    v_exp_f32 v113, v113
    v_exp_f32 v114, v114
    v_exp_f32 v115, v115
    v_mfma_f32_32x32x16_bf16 v[144:159], v[88:91], v[136:139], v[144:159]
    v_cvt_pk_bf16_f32 v140, v112, v113
    v_exp_f32 v116, v116
    v_cvt_pk_bf16_f32 v141, v114, v115
    v_exp_f32 v117, v117
    s_waitcnt lgkmcnt(0)
    v_mfma_f32_32x32x16_bf16 v[184:199], v[204:207], v[224:227], v[184:199]
    ds_read_b64_tr_b16 v[200:201], v210 offset:8192
    ds_read_b64_tr_b16 v[202:203], v210 offset:9216
    v_exp_f32 v118, v118
    v_cvt_pk_bf16_f32 v142, v116, v117
    v_exp_f32 v119, v119
    v_exp_f32 v120, v120
    v_cvt_pk_bf16_f32 v143, v118, v119
    v_exp_f32 v121, v121
    v_exp_f32 v122, v122
    v_mfma_f32_32x32x16_bf16 v[144:159], v[92:95], v[140:143], v[144:159]
    v_cvt_pk_bf16_f32 v136, v120, v121
    v_exp_f32 v123, v123
    v_exp_f32 v124, v124
    v_cvt_pk_bf16_f32 v137, v122, v123
    v_exp_f32 v125, v125
    v_exp_f32 v126, v126
    s_waitcnt vmcnt(11) lgkmcnt(0)
    v_mfma_f32_32x32x16_bf16 v[168:183], v[200:203], v[228:231], v[168:183]
    ds_read_b64_tr_b16 v[204:205], v211 offset:8192
    ds_read_b64_tr_b16 v[206:207], v211 offset:9216
    v_cvt_pk_bf16_f32 v138, v124, v125
    v_exp_f32 v127, v127
    v_exp_f32 v128, v128
    v_cvt_pk_bf16_f32 v139, v126, v127
    v_exp_f32 v129, v129
    v_exp_f32 v130, v130
    v_exp_f32 v131, v131
    v_mfma_f32_32x32x16_bf16 v[144:159], v[96:99], v[136:139], v[144:159]
    v_cvt_pk_bf16_f32 v140, v128, v129
    v_exp_f32 v132, v132
    v_cvt_pk_bf16_f32 v141, v130, v131
    v_exp_f32 v133, v133
    s_waitcnt lgkmcnt(0)
    v_mfma_f32_32x32x16_bf16 v[184:199], v[204:207], v[228:231], v[184:199]
    v_exp_f32 v134, v134
    v_cvt_pk_bf16_f32 v142, v132, v133
    v_exp_f32 v135, v135
    s_setprio 3
    v_cvt_pk_bf16_f32 v143, v134, v135
    s_waitcnt vmcnt(10)
    v_mfma_f32_32x32x16_bf16 v[104:119], v[8:11], v[160:163], 0
    v_mfma_f32_32x32x16_bf16 v[144:159], v[100:103], v[140:143], v[144:159]
    s_add_u32 s34, s7, 7
    s_and_b32 s34, s34, 7
    s_xor_b32 s34, s34, s39
    s_lshl_b32 s34, s34, 10
    s_add_u32 s34, s34, s6
    buffer_load_dwordx4 v[164:167], v2, s[24:27], s34 offen sc1
    v_xor_b32 v253, 4096, v0
    ds_read_b32 v253, v253 offset:32772
    s_nop 3
    v_mov_b32 v153, 3
    ds_write_b128 v0, v[144:147] offset:16384
    ds_write_b128 v0, v[148:151] offset:24576
    ds_write_b64 v0, v[152:153] offset:32776
    ds_read_b64 v[152:153], v7 offset:32768
    ds_read_b128 v[144:147], v7 offset:0
    ds_read_b128 v[148:151], v7 offset:8192
    s_add_u32 s59, s56, 81920
    buffer_load_dwordx4 v[212:215], v2, s[24:27], s59 offen sc1
    s_add_u32 s59, s56, 86016
    buffer_load_dwordx4 v[216:219], v2, s[24:27], s59 offen sc1
    s_waitcnt lgkmcnt(0)
    v_cmp_ne_u32 vcc, 3, v153
    s_cbranch_vccnz at_retry_29
at_back_30:
    v_cmp_gt_u32 vcc, 3, v253
    s_cbranch_vccnz mt_retry_31
mt_back_32:
    s_add_u32 m0, s58, 40960
    s_add_u32 s59, s57, 1310720
    buffer_load_dwordx4 v1, s[40:43], s59 offen lds
    s_add_u32 m0, s58, 43008
    s_add_u32 s59, s57, 1376256
    buffer_load_dwordx4 v1, s[40:43], s59 offen lds
    s_add_u32 m0, s58, 45056
    s_add_u32 s59, s2, 1
    s_and_b32 s59, s59, 7
    s_lshl_b32 s59, s59, 16
    s_add_u32 s59, s59, s57
    buffer_load_dwordx4 v1, s[44:47], s59 offen lds
    s_add_u32 m0, s58, 47104
    s_add_u32 s59, s2, 2
    s_and_b32 s59, s59, 7
    s_lshl_b32 s59, s59, 16
    s_add_u32 s59, s59, s57
    buffer_load_dwordx4 v1, s[44:47], s59 offen lds
    s_add_u32 m0, s58, 49152
    s_add_u32 s59, s2, 3
    s_and_b32 s59, s59, 7
    s_lshl_b32 s59, s59, 16
    s_add_u32 s59, s59, s57
    buffer_load_dwordx4 v1, s[44:47], s59 offen lds
    s_setprio 0
    v_exp_f32 v104, v104
    v_exp_f32 v105, v105
    v_exp_f32 v106, v106
    v_cvt_pk_bf16_f32 v136, v104, v105
    v_exp_f32 v107, v107
    v_exp_f32 v108, v108
    v_cvt_pk_bf16_f32 v137, v106, v107
    v_exp_f32 v109, v109
    v_exp_f32 v110, v110
    v_mfma_f32_32x32x16_bf16 v[120:135], v[12:15], v[160:163], 0
    v_cvt_pk_bf16_f32 v138, v108, v109
    v_exp_f32 v111, v111
    v_exp_f32 v112, v112
    v_cvt_pk_bf16_f32 v139, v110, v111
    v_exp_f32 v113, v113
    v_exp_f32 v114, v114
    v_exp_f32 v115, v115
    v_mfma_f32_32x32x16_bf16 v[144:159], v[40:43], v[136:139], v[144:159]
    v_cvt_pk_bf16_f32 v140, v112, v113
    v_exp_f32 v116, v116
    v_cvt_pk_bf16_f32 v141, v114, v115
    v_exp_f32 v117, v117
    v_exp_f32 v118, v118
    v_cvt_pk_bf16_f32 v142, v116, v117
    v_exp_f32 v119, v119
    v_exp_f32 v120, v120
    s_setprio 2
    v_cvt_pk_bf16_f32 v143, v118, v119
    v_exp_f32 v121, v121
    v_exp_f32 v122, v122
    v_mfma_f32_32x32x16_bf16 v[144:159], v[44:47], v[140:143], v[144:159]
    v_cvt_pk_bf16_f32 v136, v120, v121
    v_exp_f32 v123, v123
    v_exp_f32 v124, v124
    v_cvt_pk_bf16_f32 v137, v122, v123
    v_exp_f32 v125, v125
    v_exp_f32 v126, v126
    v_mfma_f32_32x32x16_bf16 v[104:119], v[16:19], v[160:163], 0
    v_cvt_pk_bf16_f32 v138, v124, v125
    v_exp_f32 v127, v127
    v_exp_f32 v128, v128
    v_cvt_pk_bf16_f32 v139, v126, v127
    v_exp_f32 v129, v129
    v_exp_f32 v130, v130
    v_exp_f32 v131, v131
    v_mfma_f32_32x32x16_bf16 v[144:159], v[48:51], v[136:139], v[144:159]
    v_cvt_pk_bf16_f32 v140, v128, v129
    v_exp_f32 v132, v132
    v_cvt_pk_bf16_f32 v141, v130, v131
    v_exp_f32 v133, v133
    v_exp_f32 v134, v134
    v_cvt_pk_bf16_f32 v142, v132, v133
    v_exp_f32 v135, v135
    v_exp_f32 v104, v104
    v_cvt_pk_bf16_f32 v143, v134, v135
    v_exp_f32 v105, v105
    v_exp_f32 v106, v106
    v_mfma_f32_32x32x16_bf16 v[144:159], v[52:55], v[140:143], v[144:159]
    v_cvt_pk_bf16_f32 v136, v104, v105
    v_exp_f32 v107, v107
    v_exp_f32 v108, v108
    v_cvt_pk_bf16_f32 v137, v106, v107
    v_exp_f32 v109, v109
    v_exp_f32 v110, v110
    v_mfma_f32_32x32x16_bf16 v[120:135], v[20:23], v[160:163], 0
    v_cvt_pk_bf16_f32 v138, v108, v109
    v_exp_f32 v111, v111
    v_exp_f32 v112, v112
    v_cvt_pk_bf16_f32 v139, v110, v111
    v_exp_f32 v113, v113
    v_exp_f32 v114, v114
    v_exp_f32 v115, v115
    v_mfma_f32_32x32x16_bf16 v[144:159], v[56:59], v[136:139], v[144:159]
    v_cvt_pk_bf16_f32 v140, v112, v113
    v_exp_f32 v116, v116
    v_cvt_pk_bf16_f32 v141, v114, v115
    v_exp_f32 v117, v117
    v_exp_f32 v118, v118
    v_cvt_pk_bf16_f32 v142, v116, v117
    v_exp_f32 v119, v119
    v_exp_f32 v120, v120
    v_cvt_pk_bf16_f32 v143, v118, v119
    v_exp_f32 v121, v121
    v_exp_f32 v122, v122
    v_mfma_f32_32x32x16_bf16 v[144:159], v[60:63], v[140:143], v[144:159]
    v_cvt_pk_bf16_f32 v136, v120, v121
    v_exp_f32 v123, v123
    v_exp_f32 v124, v124
    v_cvt_pk_bf16_f32 v137, v122, v123
    v_exp_f32 v125, v125
    v_exp_f32 v126, v126
    v_mfma_f32_32x32x16_bf16 v[104:119], v[24:27], v[160:163], 0
    v_cvt_pk_bf16_f32 v138, v124, v125
    v_exp_f32 v127, v127
    v_exp_f32 v128, v128
    v_cvt_pk_bf16_f32 v139, v126, v127
    v_exp_f32 v129, v129
    v_exp_f32 v130, v130
    v_exp_f32 v131, v131
    v_mfma_f32_32x32x16_bf16 v[144:159], v[64:67], v[136:139], v[144:159]
    v_cvt_pk_bf16_f32 v140, v128, v129
    v_exp_f32 v132, v132
    v_cvt_pk_bf16_f32 v141, v130, v131
    v_exp_f32 v133, v133
    v_exp_f32 v134, v134
    v_cvt_pk_bf16_f32 v142, v132, v133
    v_exp_f32 v135, v135
    v_exp_f32 v104, v104
    v_cvt_pk_bf16_f32 v143, v134, v135
    v_exp_f32 v105, v105
    v_exp_f32 v106, v106
    v_mfma_f32_32x32x16_bf16 v[144:159], v[68:71], v[140:143], v[144:159]
    v_cvt_pk_bf16_f32 v136, v104, v105
    v_exp_f32 v107, v107
    v_exp_f32 v108, v108
    v_cvt_pk_bf16_f32 v137, v106, v107
    v_exp_f32 v109, v109
    v_exp_f32 v110, v110
    v_mfma_f32_32x32x16_bf16 v[120:135], v[28:31], v[160:163], 0
    v_cvt_pk_bf16_f32 v138, v108, v109
    v_exp_f32 v111, v111
    v_exp_f32 v112, v112
    v_cvt_pk_bf16_f32 v139, v110, v111
    v_exp_f32 v113, v113
    v_exp_f32 v114, v114
    v_exp_f32 v115, v115
    v_mfma_f32_32x32x16_bf16 v[144:159], v[72:75], v[136:139], v[144:159]
    v_cvt_pk_bf16_f32 v140, v112, v113
    v_exp_f32 v116, v116
    v_cvt_pk_bf16_f32 v141, v114, v115
    v_exp_f32 v117, v117
    v_exp_f32 v118, v118
    v_cvt_pk_bf16_f32 v142, v116, v117
    v_exp_f32 v119, v119
    v_exp_f32 v120, v120
    v_cvt_pk_bf16_f32 v143, v118, v119
    v_exp_f32 v121, v121
    v_exp_f32 v122, v122
    v_mfma_f32_32x32x16_bf16 v[144:159], v[76:79], v[140:143], v[144:159]
    v_cvt_pk_bf16_f32 v136, v120, v121
    v_exp_f32 v123, v123
    v_exp_f32 v124, v124
    v_cvt_pk_bf16_f32 v137, v122, v123
    v_exp_f32 v125, v125
    v_exp_f32 v126, v126
    v_mfma_f32_32x32x16_bf16 v[104:119], v[32:35], v[160:163], 0
    v_cvt_pk_bf16_f32 v138, v124, v125
    v_exp_f32 v127, v127
    v_exp_f32 v128, v128
    v_cvt_pk_bf16_f32 v139, v126, v127
    v_exp_f32 v129, v129
    v_exp_f32 v130, v130
    v_exp_f32 v131, v131
    v_mfma_f32_32x32x16_bf16 v[144:159], v[80:83], v[136:139], v[144:159]
    v_cvt_pk_bf16_f32 v140, v128, v129
    v_exp_f32 v132, v132
    v_cvt_pk_bf16_f32 v141, v130, v131
    v_exp_f32 v133, v133
    v_exp_f32 v134, v134
    v_cvt_pk_bf16_f32 v142, v132, v133
    v_exp_f32 v135, v135
    v_exp_f32 v104, v104
    v_cvt_pk_bf16_f32 v143, v134, v135
    v_exp_f32 v105, v105
    v_exp_f32 v106, v106
    v_mfma_f32_32x32x16_bf16 v[144:159], v[84:87], v[140:143], v[144:159]
    v_cvt_pk_bf16_f32 v136, v104, v105
    v_exp_f32 v107, v107
    v_exp_f32 v108, v108
    v_cvt_pk_bf16_f32 v137, v106, v107
    v_exp_f32 v109, v109
    v_exp_f32 v110, v110
    v_mfma_f32_32x32x16_bf16 v[120:135], v[36:39], v[160:163], 0
    v_cvt_pk_bf16_f32 v138, v108, v109
    v_exp_f32 v111, v111
    v_exp_f32 v112, v112
    v_cvt_pk_bf16_f32 v139, v110, v111
    v_exp_f32 v113, v113
    v_exp_f32 v114, v114
    v_exp_f32 v115, v115
    v_mfma_f32_32x32x16_bf16 v[144:159], v[88:91], v[136:139], v[144:159]
    v_cvt_pk_bf16_f32 v140, v112, v113
    v_exp_f32 v116, v116
    v_cvt_pk_bf16_f32 v141, v114, v115
    v_exp_f32 v117, v117
    v_exp_f32 v118, v118
    v_cvt_pk_bf16_f32 v142, v116, v117
    v_exp_f32 v119, v119
    v_exp_f32 v120, v120
    v_cvt_pk_bf16_f32 v143, v118, v119
    v_exp_f32 v121, v121
    v_exp_f32 v122, v122
    v_mfma_f32_32x32x16_bf16 v[144:159], v[92:95], v[140:143], v[144:159]
    v_cvt_pk_bf16_f32 v136, v120, v121
    v_exp_f32 v123, v123
    v_exp_f32 v124, v124
    v_cvt_pk_bf16_f32 v137, v122, v123
    v_exp_f32 v125, v125
    v_exp_f32 v126, v126
    v_cvt_pk_bf16_f32 v138, v124, v125
    v_exp_f32 v127, v127
    v_exp_f32 v128, v128
    v_cvt_pk_bf16_f32 v139, v126, v127
    v_exp_f32 v129, v129
    v_exp_f32 v130, v130
    v_exp_f32 v131, v131
    v_mfma_f32_32x32x16_bf16 v[144:159], v[96:99], v[136:139], v[144:159]
    v_cvt_pk_bf16_f32 v140, v128, v129
    v_exp_f32 v132, v132
    v_cvt_pk_bf16_f32 v141, v130, v131
    v_exp_f32 v133, v133
    v_exp_f32 v134, v134
    v_cvt_pk_bf16_f32 v142, v132, v133
    v_exp_f32 v135, v135
    s_setprio 3
    v_cvt_pk_bf16_f32 v143, v134, v135
    s_waitcnt vmcnt(0)
    v_mfma_f32_32x32x16_bf16 v[104:119], v[8:11], v[164:167], 0
    v_mfma_f32_32x32x16_bf16 v[144:159], v[100:103], v[140:143], v[144:159]
    v_xor_b32 v253, 4096, v0
    ds_read_b32 v253, v253 offset:32780
    s_nop 7
    s_nop 1
    v_mov_b32 v153, 4
    ds_write_b128 v7, v[144:147] offset:0
    ds_write_b128 v7, v[148:151] offset:8192
    ds_write_b64 v7, v[152:153] offset:32768
    ds_read_b64 v[152:153], v7 offset:32776
    ds_read_b128 v[144:147], v7 offset:16384
    ds_read_b128 v[148:151], v7 offset:24576
    s_waitcnt lgkmcnt(0)
    v_cmp_ne_u32 vcc, 3, v153
    s_cbranch_vccnz at_retry_33
at_back_34:
    v_cmp_gt_u32 vcc, 3, v253
    s_cbranch_vccnz mt_retry_35
mt_back_36:
    s_add_u32 m0, s58, 81920
    s_add_u32 s59, s2, 4
    s_and_b32 s59, s59, 7
    s_lshl_b32 s59, s59, 16
    s_add_u32 s59, s59, s57
    buffer_load_dwordx4 v1, s[44:47], s59 offen lds
    s_add_u32 m0, s58, 83968
    s_add_u32 s59, s2, 5
    s_and_b32 s59, s59, 7
    s_lshl_b32 s59, s59, 16
    s_add_u32 s59, s59, s57
    buffer_load_dwordx4 v1, s[44:47], s59 offen lds
    s_add_u32 m0, s58, 86016
    s_add_u32 s59, s2, 6
    s_and_b32 s59, s59, 7
    s_lshl_b32 s59, s59, 16
    s_add_u32 s59, s59, s57
    buffer_load_dwordx4 v1, s[44:47], s59 offen lds
    s_add_u32 m0, s58, 88064
    s_add_u32 s59, s2, 7
    s_and_b32 s59, s59, 7
    s_lshl_b32 s59, s59, 16
    s_add_u32 s59, s59, s57
    buffer_load_dwordx4 v1, s[44:47], s59 offen lds
    s_add_u32 m0, s58, 90112
    s_add_u32 s59, s2, 8
    s_and_b32 s59, s59, 7
    s_lshl_b32 s59, s59, 16
    s_add_u32 s59, s59, s57
    buffer_load_dwordx4 v1, s[44:47], s59 offen lds
    s_setprio 0
    s_lshl_b32 s56, s52, 5
    s_add_u32 s56, s56, s54
    s_lshl_b32 s56, s56, 10
    s_add_u32 s56, s56, 6291456
    v_exp_f32 v104, v104
    v_exp_f32 v105, v105
    v_exp_f32 v106, v106
    v_cvt_pk_bf16_f32 v136, v104, v105
    v_exp_f32 v107, v107
    v_exp_f32 v108, v108
    v_cvt_pk_bf16_f32 v137, v106, v107
    v_exp_f32 v109, v109
    v_exp_f32 v110, v110
    v_mfma_f32_32x32x16_bf16 v[120:135], v[12:15], v[164:167], 0
    v_cvt_pk_bf16_f32 v138, v108, v109
    v_exp_f32 v111, v111
    v_exp_f32 v112, v112
    v_cvt_pk_bf16_f32 v139, v110, v111
    v_exp_f32 v113, v113
    v_exp_f32 v114, v114
    v_exp_f32 v115, v115
    v_mfma_f32_32x32x16_bf16 v[144:159], v[40:43], v[136:139], v[144:159]
    v_cvt_pk_bf16_f32 v140, v112, v113
    v_exp_f32 v116, v116
    v_cvt_pk_bf16_f32 v141, v114, v115
    v_exp_f32 v117, v117
    v_exp_f32 v118, v118
    v_cvt_pk_bf16_f32 v142, v116, v117
    v_exp_f32 v119, v119
    v_exp_f32 v120, v120
    s_setprio 2
    v_cvt_pk_bf16_f32 v143, v118, v119
    v_exp_f32 v121, v121
    v_exp_f32 v122, v122
    v_mfma_f32_32x32x16_bf16 v[144:159], v[44:47], v[140:143], v[144:159]
    v_cvt_pk_bf16_f32 v136, v120, v121
    v_exp_f32 v123, v123
    v_exp_f32 v124, v124
    v_cvt_pk_bf16_f32 v137, v122, v123
    v_exp_f32 v125, v125
    v_exp_f32 v126, v126
    v_mfma_f32_32x32x16_bf16 v[104:119], v[16:19], v[164:167], 0
    v_cvt_pk_bf16_f32 v138, v124, v125
    v_exp_f32 v127, v127
    v_exp_f32 v128, v128
    v_cvt_pk_bf16_f32 v139, v126, v127
    v_exp_f32 v129, v129
    v_exp_f32 v130, v130
    v_exp_f32 v131, v131
    v_mfma_f32_32x32x16_bf16 v[144:159], v[48:51], v[136:139], v[144:159]
    v_cvt_pk_bf16_f32 v140, v128, v129
    v_exp_f32 v132, v132
    v_cvt_pk_bf16_f32 v141, v130, v131
    v_exp_f32 v133, v133
    v_exp_f32 v134, v134
    v_cvt_pk_bf16_f32 v142, v132, v133
    v_exp_f32 v135, v135
    v_exp_f32 v104, v104
    v_cvt_pk_bf16_f32 v143, v134, v135
    v_exp_f32 v105, v105
    v_exp_f32 v106, v106
    v_mfma_f32_32x32x16_bf16 v[144:159], v[52:55], v[140:143], v[144:159]
    v_cvt_pk_bf16_f32 v136, v104, v105
    v_exp_f32 v107, v107
    v_exp_f32 v108, v108
    v_cvt_pk_bf16_f32 v137, v106, v107
    v_exp_f32 v109, v109
    v_exp_f32 v110, v110
    v_mfma_f32_32x32x16_bf16 v[120:135], v[20:23], v[164:167], 0
    v_cvt_pk_bf16_f32 v138, v108, v109
    v_exp_f32 v111, v111
    v_exp_f32 v112, v112
    v_cvt_pk_bf16_f32 v139, v110, v111
    v_exp_f32 v113, v113
    v_exp_f32 v114, v114
    v_exp_f32 v115, v115
    v_mfma_f32_32x32x16_bf16 v[144:159], v[56:59], v[136:139], v[144:159]
    v_cvt_pk_bf16_f32 v140, v112, v113
    v_exp_f32 v116, v116
    v_cvt_pk_bf16_f32 v141, v114, v115
    v_exp_f32 v117, v117
    v_exp_f32 v118, v118
    v_cvt_pk_bf16_f32 v142, v116, v117
    v_exp_f32 v119, v119
    v_exp_f32 v120, v120
    v_cvt_pk_bf16_f32 v143, v118, v119
    v_exp_f32 v121, v121
    v_exp_f32 v122, v122
    v_mfma_f32_32x32x16_bf16 v[144:159], v[60:63], v[140:143], v[144:159]
    v_cvt_pk_bf16_f32 v136, v120, v121
    v_exp_f32 v123, v123
    v_exp_f32 v124, v124
    v_cvt_pk_bf16_f32 v137, v122, v123
    v_exp_f32 v125, v125
    v_exp_f32 v126, v126
    v_mfma_f32_32x32x16_bf16 v[104:119], v[24:27], v[164:167], 0
    v_cvt_pk_bf16_f32 v138, v124, v125
    v_exp_f32 v127, v127
    v_exp_f32 v128, v128
    v_cvt_pk_bf16_f32 v139, v126, v127
    v_exp_f32 v129, v129
    v_exp_f32 v130, v130
    v_exp_f32 v131, v131
    v_mfma_f32_32x32x16_bf16 v[144:159], v[64:67], v[136:139], v[144:159]
    v_cvt_pk_bf16_f32 v140, v128, v129
    v_exp_f32 v132, v132
    v_cvt_pk_bf16_f32 v141, v130, v131
    v_exp_f32 v133, v133
    v_exp_f32 v134, v134
    v_cvt_pk_bf16_f32 v142, v132, v133
    v_exp_f32 v135, v135
    v_exp_f32 v104, v104
    v_cvt_pk_bf16_f32 v143, v134, v135
    v_exp_f32 v105, v105
    v_exp_f32 v106, v106
    v_mfma_f32_32x32x16_bf16 v[144:159], v[68:71], v[140:143], v[144:159]
    v_cvt_pk_bf16_f32 v136, v104, v105
    v_exp_f32 v107, v107
    v_exp_f32 v108, v108
    v_cvt_pk_bf16_f32 v137, v106, v107
    v_exp_f32 v109, v109
    v_exp_f32 v110, v110
    v_mfma_f32_32x32x16_bf16 v[120:135], v[28:31], v[164:167], 0
    v_cvt_pk_bf16_f32 v138, v108, v109
    v_exp_f32 v111, v111
    v_exp_f32 v112, v112
    v_cvt_pk_bf16_f32 v139, v110, v111
    v_exp_f32 v113, v113
    v_exp_f32 v114, v114
    v_exp_f32 v115, v115
    v_mfma_f32_32x32x16_bf16 v[144:159], v[72:75], v[136:139], v[144:159]
    v_cvt_pk_bf16_f32 v140, v112, v113
    v_exp_f32 v116, v116
    v_cvt_pk_bf16_f32 v141, v114, v115
    v_exp_f32 v117, v117
    v_exp_f32 v118, v118
    v_cvt_pk_bf16_f32 v142, v116, v117
    v_exp_f32 v119, v119
    v_exp_f32 v120, v120
    v_cvt_pk_bf16_f32 v143, v118, v119
    v_exp_f32 v121, v121
    v_exp_f32 v122, v122
    v_mfma_f32_32x32x16_bf16 v[144:159], v[76:79], v[140:143], v[144:159]
    v_cvt_pk_bf16_f32 v136, v120, v121
    v_exp_f32 v123, v123
    v_exp_f32 v124, v124
    v_cvt_pk_bf16_f32 v137, v122, v123
    v_exp_f32 v125, v125
    v_exp_f32 v126, v126
    v_mfma_f32_32x32x16_bf16 v[104:119], v[32:35], v[164:167], 0
    v_cvt_pk_bf16_f32 v138, v124, v125
    v_exp_f32 v127, v127
    v_exp_f32 v128, v128
    v_cvt_pk_bf16_f32 v139, v126, v127
    v_exp_f32 v129, v129
    v_exp_f32 v130, v130
    v_exp_f32 v131, v131
    v_mfma_f32_32x32x16_bf16 v[144:159], v[80:83], v[136:139], v[144:159]
    v_cvt_pk_bf16_f32 v140, v128, v129
    v_exp_f32 v132, v132
    v_cvt_pk_bf16_f32 v141, v130, v131
    v_exp_f32 v133, v133
    v_exp_f32 v134, v134
    v_cvt_pk_bf16_f32 v142, v132, v133
    v_exp_f32 v135, v135
    v_exp_f32 v104, v104
    v_cvt_pk_bf16_f32 v143, v134, v135
    v_exp_f32 v105, v105
    v_exp_f32 v106, v106
    v_mfma_f32_32x32x16_bf16 v[144:159], v[84:87], v[140:143], v[144:159]
    v_cvt_pk_bf16_f32 v136, v104, v105
    v_exp_f32 v107, v107
    v_exp_f32 v108, v108
    v_cvt_pk_bf16_f32 v137, v106, v107
    v_exp_f32 v109, v109
    v_exp_f32 v110, v110
    v_mfma_f32_32x32x16_bf16 v[120:135], v[36:39], v[164:167], 0
    v_cvt_pk_bf16_f32 v138, v108, v109
    v_exp_f32 v111, v111
    v_exp_f32 v112, v112
    v_cvt_pk_bf16_f32 v139, v110, v111
    v_exp_f32 v113, v113
    v_exp_f32 v114, v114
    v_exp_f32 v115, v115
    v_mfma_f32_32x32x16_bf16 v[144:159], v[88:91], v[136:139], v[144:159]
    v_cvt_pk_bf16_f32 v140, v112, v113
    v_exp_f32 v116, v116
    v_cvt_pk_bf16_f32 v141, v114, v115
    v_exp_f32 v117, v117
    v_exp_f32 v118, v118
    v_cvt_pk_bf16_f32 v142, v116, v117
    v_exp_f32 v119, v119
    v_exp_f32 v120, v120
    v_cvt_pk_bf16_f32 v143, v118, v119
    v_exp_f32 v121, v121
    v_exp_f32 v122, v122
    v_mfma_f32_32x32x16_bf16 v[144:159], v[92:95], v[140:143], v[144:159]
    v_cvt_pk_bf16_f32 v136, v120, v121
    v_exp_f32 v123, v123
    v_exp_f32 v124, v124
    v_cvt_pk_bf16_f32 v137, v122, v123
    v_exp_f32 v125, v125
    v_exp_f32 v126, v126
    v_cvt_pk_bf16_f32 v138, v124, v125
    v_exp_f32 v127, v127
    v_exp_f32 v128, v128
    v_cvt_pk_bf16_f32 v139, v126, v127
    v_exp_f32 v129, v129
    v_exp_f32 v130, v130
    v_exp_f32 v131, v131
    v_mfma_f32_32x32x16_bf16 v[144:159], v[96:99], v[136:139], v[144:159]
    v_cvt_pk_bf16_f32 v140, v128, v129
    v_exp_f32 v132, v132
    v_cvt_pk_bf16_f32 v141, v130, v131
    v_exp_f32 v133, v133
    v_exp_f32 v134, v134
    v_cvt_pk_bf16_f32 v142, v132, v133
    v_exp_f32 v135, v135
    s_setprio 3
    v_cvt_pk_bf16_f32 v143, v134, v135
    s_mov_b32 s74, 0x21800000
    s_mov_b32 s75, 0x7b800000
    v_mfma_f32_32x32x16_bf16 v[144:159], v[100:103], v[140:143], v[144:159]
    v_xor_b32 v7, 4096, v7
    ds_read_b64 v[112:113], v7 offset:32768
    ds_read_b128 v[104:107], v7 offset:0
    ds_read_b128 v[108:111], v7 offset:8192
    s_lshl_b32 s34, s35, 5
    s_add_u32 s34, s34, s4
    s_lshl_b32 s34, s34, 10
    s_add_u32 s34, s34, 6291456
    s_nop 0
    s_waitcnt lgkmcnt(0)
    v_cmp_ne_u32 vcc, 4, v113
    s_cbranch_vccnz at_retry_37
at_back_38:
    s_mov_b32 s36, 0
    ds_read_b64_tr_b16 v[48:49], v208 offset:0
    ds_read_b64_tr_b16 v[50:51], v208 offset:1024
    ds_read_b64_tr_b16 v[52:53], v209 offset:0
    ds_read_b64_tr_b16 v[54:55], v209 offset:1024
    ds_read_b64_tr_b16 v[56:57], v208 offset:2048
    ds_read_b64_tr_b16 v[58:59], v208 offset:3072
    ds_read_b64_tr_b16 v[60:61], v209 offset:2048
    ds_read_b64_tr_b16 v[62:63], v209 offset:3072
    ds_read_b64_tr_b16 v[64:65], v208 offset:4096
    ds_read_b64_tr_b16 v[66:67], v208 offset:5120
    ds_read_b64_tr_b16 v[68:69], v209 offset:4096
    ds_read_b64_tr_b16 v[70:71], v209 offset:5120
    v_add_f32 v144, v144, v104
    v_add_f32 v145, v145, v105
    v_add_f32 v146, v146, v106
    v_add_f32 v147, v147, v107
    v_add_f32 v148, v148, v108
    v_add_f32 v149, v149, v109
    v_add_f32 v150, v150, v110
    v_add_f32 v151, v151, v111
    v_add_f32 v152, v152, v112
    v_mul_f32 v7, 0, v144
    v_fma_f32 v7, v145, 0, v7
    v_fma_f32 v7, v146, 0, v7
    v_fma_f32 v7, v147, 0, v7
    v_fma_f32 v7, v148, 0, v7
    v_fma_f32 v7, v149, 0, v7
    v_fma_f32 v7, v150, 0, v7
    v_fma_f32 v7, v151, 0, v7
    v_add_f32 v7, v7, v152
    v_cmp_le_f32 vcc, s74, v7
    v_cmp_ge_f32 s[28:29], s75, v7
    s_and_b64 vcc, vcc, s[28:29]
    s_andn2_b64 s[28:29], exec, vcc
    s_cbranch_scc1 at_fb_40
at_fin_39:
    v_rcp_f32 v7, v152
    s_nop 0
    v_mul_f32 v7, v7, v6
    v_mul_f32 v144, v144, v7
    v_mul_f32 v145, v145, v7
    v_mul_f32 v146, v146, v7
    v_mul_f32 v147, v147, v7
    v_mul_f32 v148, v148, v7
    v_mul_f32 v149, v149, v7
    v_mul_f32 v150, v150, v7
    v_mul_f32 v151, v151, v7
    v_cvt_pk_bf16_f32 v136, v144, v145
    v_cvt_pk_bf16_f32 v137, v146, v147
    v_cvt_pk_bf16_f32 v138, v148, v149
    v_cvt_pk_bf16_f32 v139, v150, v151
    buffer_store_dwordx4 v[136:139], v2, s[24:27], s34 offen sc1
    s_setprio 0
    s_waitcnt vmcnt(1)
    s_cmp_eq_u32 s55, 0
    s_cbranch_scc1 p4_nl_41
    s_add_u32 s59, s2, 1
    s_and_b32 s59, s59, 7
    s_lshl_b32 s59, s59, 12
    s_add_u32 s59, s59, s56
    buffer_load_dwordx4 v[8:11], v2, s[24:27], s59 offen sc1
    s_add_u32 s59, s2, 2
    s_and_b32 s59, s59, 7
    s_lshl_b32 s59, s59, 12
    s_add_u32 s59, s59, s56
    buffer_load_dwordx4 v[12:15], v2, s[24:27], s59 offen sc1
    s_add_u32 s59, s2, 3
    s_and_b32 s59, s59, 7
    s_lshl_b32 s59, s59, 12
    s_add_u32 s59, s59, s56
    buffer_load_dwordx4 v[16:19], v2, s[24:27], s59 offen sc1
p4_nl_41:
    s_waitcnt lgkmcnt(8)
    v_mfma_f32_32x32x16_bf16 v[168:183], v[48:51], v[232:235], v[168:183]
    v_mfma_f32_32x32x16_bf16 v[184:199], v[52:55], v[232:235], v[184:199]
    ds_read_b64_tr_b16 v[72:73], v208 offset:6144
    ds_read_b64_tr_b16 v[74:75], v208 offset:7168
    ds_read_b64_tr_b16 v[76:77], v209 offset:6144
    ds_read_b64_tr_b16 v[78:79], v209 offset:7168
    s_cmp_eq_u32 s55, 0
    s_cbranch_scc1 p4_nl_42
    s_add_u32 s59, s2, 4
    s_and_b32 s59, s59, 7
    s_lshl_b32 s59, s59, 12
    s_add_u32 s59, s59, s56
    buffer_load_dwordx4 v[20:23], v2, s[24:27], s59 offen sc1
    s_add_u32 s59, s2, 5
    s_and_b32 s59, s59, 7
    s_lshl_b32 s59, s59, 12
    s_add_u32 s59, s59, s56
    buffer_load_dwordx4 v[24:27], v2, s[24:27], s59 offen sc1
p4_nl_42:
    s_waitcnt lgkmcnt(8)
    v_mfma_f32_32x32x16_bf16 v[168:183], v[56:59], v[236:239], v[168:183]
    v_mfma_f32_32x32x16_bf16 v[184:199], v[60:63], v[236:239], v[184:199]
    ds_read_b64_tr_b16 v[80:81], v208 offset:8192
    ds_read_b64_tr_b16 v[82:83], v208 offset:9216
    ds_read_b64_tr_b16 v[84:85], v209 offset:8192
    ds_read_b64_tr_b16 v[86:87], v209 offset:9216
    s_cmp_eq_u32 s55, 0
    s_cbranch_scc1 p4_nl_43
    s_add_u32 s59, s2, 6
    s_and_b32 s59, s59, 7
    s_lshl_b32 s59, s59, 12
    s_add_u32 s59, s59, s56
    buffer_load_dwordx4 v[28:31], v2, s[24:27], s59 offen sc1
    s_add_u32 s59, s2, 7
    s_and_b32 s59, s59, 7
    s_lshl_b32 s59, s59, 12
    s_add_u32 s59, s59, s56
    buffer_load_dwordx4 v[32:35], v2, s[24:27], s59 offen sc1
p4_nl_43:
    s_waitcnt lgkmcnt(8)
    v_mfma_f32_32x32x16_bf16 v[168:183], v[64:67], v[240:243], v[168:183]
    v_mfma_f32_32x32x16_bf16 v[184:199], v[68:71], v[240:243], v[184:199]
    ds_read_b64_tr_b16 v[88:89], v208 offset:40960
    ds_read_b64_tr_b16 v[90:91], v208 offset:41984
    ds_read_b64_tr_b16 v[92:93], v209 offset:40960
    ds_read_b64_tr_b16 v[94:95], v209 offset:41984
    s_cmp_eq_u32 s55, 0
    s_cbranch_scc1 p4_nl_44
    s_add_u32 s59, s2, 8
    s_and_b32 s59, s59, 7
    s_lshl_b32 s59, s59, 12
    s_add_u32 s59, s59, s56
    buffer_load_dwordx4 v[36:39], v2, s[24:27], s59 offen sc1
p4_nl_44:
    s_waitcnt lgkmcnt(8)
    v_mfma_f32_32x32x16_bf16 v[168:183], v[72:75], v[244:247], v[168:183]
    v_mfma_f32_32x32x16_bf16 v[184:199], v[76:79], v[244:247], v[184:199]
    ds_read_b64_tr_b16 v[96:97], v208 offset:43008
    ds_read_b64_tr_b16 v[98:99], v208 offset:44032
    ds_read_b64_tr_b16 v[100:101], v209 offset:43008
    ds_read_b64_tr_b16 v[102:103], v209 offset:44032
    s_waitcnt lgkmcnt(8)
    v_mfma_f32_32x32x16_bf16 v[168:183], v[80:83], v[248:251], v[168:183]
    v_mfma_f32_32x32x16_bf16 v[184:199], v[84:87], v[248:251], v[184:199]
    s_cmp_lg_u32 s55, 1
    s_cbranch_scc1 p4_nb_45
    s_barrier
p4_nb_45:
    ds_read_b64_tr_b16 v[40:41], v208 offset:45056
    ds_read_b64_tr_b16 v[42:43], v208 offset:46080
    ds_read_b64_tr_b16 v[44:45], v209 offset:45056
    ds_read_b64_tr_b16 v[46:47], v209 offset:46080
    s_waitcnt lgkmcnt(8)
    v_mfma_f32_32x32x16_bf16 v[168:183], v[88:91], v[212:215], v[168:183]
    v_mfma_f32_32x32x16_bf16 v[184:199], v[92:95], v[212:215], v[184:199]
    ds_read_b64_tr_b16 v[48:49], v208 offset:47104
    ds_read_b64_tr_b16 v[50:51], v208 offset:48128
    ds_read_b64_tr_b16 v[52:53], v209 offset:47104
    ds_read_b64_tr_b16 v[54:55], v209 offset:48128
    s_waitcnt lgkmcnt(8)
    s_cmp_ge_u32 s54, 2
    s_cbranch_scc1 p4_sk_46
    v_mfma_f32_32x32x16_bf16 v[168:183], v[96:99], v[216:219], v[168:183]
    v_mfma_f32_32x32x16_bf16 v[184:199], v[100:103], v[216:219], v[184:199]
p4_sk_46:
    s_cmp_lg_u32 s55, 0
    s_cbranch_scc1 p4_nb_47
    s_barrier
    s_add_u32 s59, s2, 1
    s_and_b32 s59, s59, 7
    s_lshl_b32 s59, s59, 12
    s_add_u32 s59, s59, s56
    buffer_load_dwordx4 v[8:11], v2, s[24:27], s59 offen sc1
    s_add_u32 s59, s2, 2
    s_and_b32 s59, s59, 7
    s_lshl_b32 s59, s59, 12
    s_add_u32 s59, s59, s56
    buffer_load_dwordx4 v[12:15], v2, s[24:27], s59 offen sc1
    s_add_u32 s59, s2, 3
    s_and_b32 s59, s59, 7
    s_lshl_b32 s59, s59, 12
    s_add_u32 s59, s59, s56
    buffer_load_dwordx4 v[16:19], v2, s[24:27], s59 offen sc1
    s_add_u32 s59, s2, 4
    s_and_b32 s59, s59, 7
    s_lshl_b32 s59, s59, 12
    s_add_u32 s59, s59, s56
    buffer_load_dwordx4 v[20:23], v2, s[24:27], s59 offen sc1
    s_add_u32 s59, s2, 5
    s_and_b32 s59, s59, 7
    s_lshl_b32 s59, s59, 12
    s_add_u32 s59, s59, s56
    buffer_load_dwordx4 v[24:27], v2, s[24:27], s59 offen sc1
    s_add_u32 s59, s2, 6
    s_and_b32 s59, s59, 7
    s_lshl_b32 s59, s59, 12
    s_add_u32 s59, s59, s56
    buffer_load_dwordx4 v[28:31], v2, s[24:27], s59 offen sc1
    s_add_u32 s59, s2, 7
    s_and_b32 s59, s59, 7
    s_lshl_b32 s59, s59, 12
    s_add_u32 s59, s59, s56
    buffer_load_dwordx4 v[32:35], v2, s[24:27], s59 offen sc1
    s_add_u32 s59, s2, 8
    s_and_b32 s59, s59, 7
    s_lshl_b32 s59, s59, 12
    s_add_u32 s59, s59, s56
    buffer_load_dwordx4 v[36:39], v2, s[24:27], s59 offen sc1
p4_nb_47:
    ds_read_b64_tr_b16 v[56:57], v208 offset:49152
    ds_read_b64_tr_b16 v[58:59], v208 offset:50176
    ds_read_b64_tr_b16 v[60:61], v209 offset:49152
    ds_read_b64_tr_b16 v[62:63], v209 offset:50176
    s_waitcnt vmcnt(7) lgkmcnt(8)
    v_max3_u32 v112, v8, v9, v10
    v_max_u32 v112, v11, v112
    v_cmp_eq_u32 vcc, -1, v112
    s_bitset1_b32 s36, 0
    s_cbranch_vccnz p4_miss_48
    s_bitset0_b32 s36, 0
    v_mfma_f32_32x32x16_bf16 v[168:183], v[40:43], v[8:11], v[168:183]
    v_mfma_f32_32x32x16_bf16 v[184:199], v[44:47], v[8:11], v[184:199]
p4_miss_48:
    ds_read_b64_tr_b16 v[64:65], v210 offset:0
    ds_read_b64_tr_b16 v[66:67], v210 offset:1024
    ds_read_b64_tr_b16 v[68:69], v211 offset:0
    ds_read_b64_tr_b16 v[70:71], v211 offset:1024
    s_waitcnt vmcnt(6) lgkmcnt(8)
    v_max3_u32 v112, v12, v13, v14
    v_max_u32 v112, v15, v112
    v_cmp_eq_u32 vcc, -1, v112
    s_bitset1_b32 s36, 1
    s_cbranch_vccnz p4_miss_49
    s_bitset0_b32 s36, 1
    v_mfma_f32_32x32x16_bf16 v[168:183], v[48:51], v[12:15], v[168:183]
    v_mfma_f32_32x32x16_bf16 v[184:199], v[52:55], v[12:15], v[184:199]
p4_miss_49:
    ds_read_b64_tr_b16 v[72:73], v210 offset:2048
    ds_read_b64_tr_b16 v[74:75], v210 offset:3072
    ds_read_b64_tr_b16 v[76:77], v211 offset:2048
    ds_read_b64_tr_b16 v[78:79], v211 offset:3072
    s_waitcnt vmcnt(5) lgkmcnt(8)
    v_max3_u32 v112, v16, v17, v18
    v_max_u32 v112, v19, v112
    v_cmp_eq_u32 vcc, -1, v112
    s_bitset1_b32 s36, 2
    s_cbranch_vccnz p4_miss_50
    s_bitset0_b32 s36, 2
    v_mfma_f32_32x32x16_bf16 v[168:183], v[56:59], v[16:19], v[168:183]
    v_mfma_f32_32x32x16_bf16 v[184:199], v[60:63], v[16:19], v[184:199]
p4_miss_50:
    ds_read_b64_tr_b16 v[80:81], v210 offset:4096
    ds_read_b64_tr_b16 v[82:83], v210 offset:5120
    ds_read_b64_tr_b16 v[84:85], v211 offset:4096
    ds_read_b64_tr_b16 v[86:87], v211 offset:5120
    s_waitcnt vmcnt(4) lgkmcnt(8)
    v_max3_u32 v112, v20, v21, v22
    v_max_u32 v112, v23, v112
    v_cmp_eq_u32 vcc, -1, v112
    s_bitset1_b32 s36, 3
    s_cbranch_vccnz p4_miss_51
    s_bitset0_b32 s36, 3
    v_mfma_f32_32x32x16_bf16 v[168:183], v[64:67], v[20:23], v[168:183]
    v_mfma_f32_32x32x16_bf16 v[184:199], v[68:71], v[20:23], v[184:199]
p4_miss_51:
    ds_read_b64_tr_b16 v[88:89], v210 offset:6144
    ds_read_b64_tr_b16 v[90:91], v210 offset:7168
    ds_read_b64_tr_b16 v[92:93], v211 offset:6144
    ds_read_b64_tr_b16 v[94:95], v211 offset:7168
    s_waitcnt vmcnt(3) lgkmcnt(8)
    v_max3_u32 v112, v24, v25, v26
    v_max_u32 v112, v27, v112
    v_cmp_eq_u32 vcc, -1, v112
    s_bitset1_b32 s36, 4
    s_cbranch_vccnz p4_miss_52
    s_bitset0_b32 s36, 4
    v_mfma_f32_32x32x16_bf16 v[168:183], v[72:75], v[24:27], v[168:183]
    v_mfma_f32_32x32x16_bf16 v[184:199], v[76:79], v[24:27], v[184:199]
p4_miss_52:
    ds_read_b64_tr_b16 v[96:97], v210 offset:8192
    ds_read_b64_tr_b16 v[98:99], v210 offset:9216
    ds_read_b64_tr_b16 v[100:101], v211 offset:8192
    ds_read_b64_tr_b16 v[102:103], v211 offset:9216
    s_waitcnt vmcnt(2) lgkmcnt(8)
    v_max3_u32 v112, v28, v29, v30
    v_max_u32 v112, v31, v112
    v_cmp_eq_u32 vcc, -1, v112
    s_bitset1_b32 s36, 5
    s_cbranch_vccnz p4_miss_53
    s_bitset0_b32 s36, 5
    v_mfma_f32_32x32x16_bf16 v[168:183], v[80:83], v[28:31], v[168:183]
    v_mfma_f32_32x32x16_bf16 v[184:199], v[84:87], v[28:31], v[184:199]
p4_miss_53:
    s_waitcnt vmcnt(1) lgkmcnt(4)
    v_max3_u32 v112, v32, v33, v34
    v_max_u32 v112, v35, v112
    v_cmp_eq_u32 vcc, -1, v112
    s_bitset1_b32 s36, 6
    s_cbranch_vccnz p4_miss_54
    s_bitset0_b32 s36, 6
    v_mfma_f32_32x32x16_bf16 v[168:183], v[88:91], v[32:35], v[168:183]
    v_mfma_f32_32x32x16_bf16 v[184:199], v[92:95], v[32:35], v[184:199]
p4_miss_54:
    s_waitcnt vmcnt(0) lgkmcnt(0)
    v_max3_u32 v112, v36, v37, v38
    v_max_u32 v112, v39, v112
    v_cmp_eq_u32 vcc, -1, v112
    s_bitset1_b32 s36, 7
    s_cbranch_vccnz p4_miss_55
    s_bitset0_b32 s36, 7
    v_mfma_f32_32x32x16_bf16 v[168:183], v[96:99], v[36:39], v[168:183]
    v_mfma_f32_32x32x16_bf16 v[184:199], v[100:103], v[36:39], v[184:199]
p4_miss_55:
    s_cmp_lg_u32 s36, 0
    s_cbranch_scc1 p4_again_56
p4_done_57:
    s_mul_i32 s57, s55, -122880
    s_add_u32 s57, s57, 122880
    s_xor_b32 s59, s54, 1
    s_mul_i32 s59, s59, 6144
    s_add_u32 s59, s59, s57
    v_add_u32 v209, s59, v2
    s_xor_b32 s59, s54, 2
    s_mul_i32 s59, s59, 6144
    s_add_u32 s59, s59, s57
    v_add_u32 v210, s59, v2
    s_xor_b32 s59, s54, 3
    s_mul_i32 s59, s59, 6144
    s_add_u32 s59, s59, s57
    v_add_u32 v211, s59, v2
    s_mul_i32 s59, s54, 6144
    s_add_u32 s59, s59, s57
    v_add_u32 v208, s59, v2
    ds_write_b128 v209, v[176:179] offset:0
    ds_write_b128 v209, v[180:183] offset:1024
    ds_write_b128 v210, v[184:187] offset:2048
    ds_write_b128 v210, v[188:191] offset:3072
    ds_write_b128 v211, v[192:195] offset:4096
    ds_write_b128 v211, v[196:199] offset:5120
    v_and_b32 v72, 0x1f0, v2
    v_lshlrev_b32 v72, 6, v72
    v_lshrrev_b32 v73, 3, v2
    v_and_b32 v73, 64, v73
    v_add_u32 v72, v72, v73
    s_lshl_b32 s59, s52, 15
    s_lshl_b32 s57, s53, 7
    s_add_u32 s59, s59, s57
    s_lshl_b32 s57, s54, 4
    s_add_u32 s59, s59, s57
    s_waitcnt lgkmcnt(0)
    s_barrier
    ds_read_b128 v[176:179], v208 offset:0
    ds_read_b128 v[180:183], v208 offset:1024
    ds_read_b128 v[184:187], v208 offset:2048
    ds_read_b128 v[188:191], v208 offset:3072
    ds_read_b128 v[192:195], v208 offset:4096
    ds_read_b128 v[196:199], v208 offset:5120
    s_waitcnt lgkmcnt(4)
    v_pk_add_f32 v[168:169], v[168:169], v[176:177]
    v_pk_add_f32 v[170:171], v[170:171], v[178:179]
    v_pk_add_f32 v[172:173], v[172:173], v[180:181]
    v_pk_add_f32 v[174:175], v[174:175], v[182:183]
    s_waitcnt lgkmcnt(2)
    v_pk_add_f32 v[168:169], v[168:169], v[184:185]
    v_pk_add_f32 v[170:171], v[170:171], v[186:187]
    v_pk_add_f32 v[172:173], v[172:173], v[188:189]
    v_pk_add_f32 v[174:175], v[174:175], v[190:191]
    s_waitcnt lgkmcnt(0)
    v_pk_add_f32 v[168:169], v[168:169], v[192:193]
    v_pk_add_f32 v[170:171], v[170:171], v[194:195]
    v_pk_add_f32 v[172:173], v[172:173], v[196:197]
    v_pk_add_f32 v[174:175], v[174:175], v[198:199]
    v_cvt_pk_bf16_f32 v176, v168, v169
    v_cvt_pk_bf16_f32 v177, v170, v171
    v_cvt_pk_bf16_f32 v178, v172, v173
    v_cvt_pk_bf16_f32 v179, v174, v175
    buffer_store_dwordx4 v[176:179], v72, s[48:51], s59 offen nt
    s_or_b32 s59, s2, s3
    s_cbranch_scc1 noepoch_58
    s_mov_b32 s59, 14778368
    v_mov_b32 v0, s100
    s_mov_b64 exec, 1
    buffer_store_dword v0, off, s[24:27], s59 sc1
noepoch_58:
exit_1:
    s_endpgm
retry_7:
    s_mov_b32 s37, 131072
rl_59:
    s_sleep 2
    buffer_load_dword v139, v138, s[24:27], s60 offen sc1
    s_sub_u32 s37, s37, 1
    s_waitcnt vmcnt(0) lgkmcnt(0)
    s_cbranch_scc1 back_8
    v_cmp_ne_u32 vcc, s100, v139
    s_cbranch_vccnz rl_59
    s_branch back_8
retry_9:
    s_mov_b32 s37, 131072
rl_60:
    s_sleep 2
    buffer_load_dword v139, v138, s[24:27], s60 offen sc1
    s_sub_u32 s37, s37, 1
    s_waitcnt vmcnt(0) lgkmcnt(0)
    s_cbranch_scc1 back_10
    v_cmp_ne_u32 vcc, s100, v139
    s_cbranch_vccnz rl_60
    s_branch back_10
retry_11:
    s_mov_b32 s37, 131072
rl_61:
    s_sleep 2
    ds_read_b32 v252, v253
    s_sub_u32 s37, s37, 1
    s_waitcnt vmcnt(0) lgkmcnt(0)
    s_cbranch_scc1 back_12
    v_cmp_eq_u32 vcc, -1, v252
    s_cbranch_vccnz rl_61
    s_branch back_12
at_retry_13:
    s_mov_b32 s37, 0x100000
at_rl_62:
    s_sleep 2
    ds_read_b64 v[152:153], v5 offset:32768
    ds_read_b128 v[144:147], v5 offset:0
    ds_read_b128 v[148:151], v5 offset:8192
    s_sub_u32 s37, s37, 1
    s_waitcnt lgkmcnt(0)
    s_cbranch_scc1 at_back_14
    v_cmp_ne_u32 vcc, 1, v153
    s_cbranch_vccnz at_rl_62
    s_branch at_back_14
retry_15:
    s_mov_b32 s37, 131072
rl_63:
    s_sleep 2
    buffer_load_dword v255, v254, s[24:27], s61 offen sc1
    s_sub_u32 s37, s37, 1
    s_waitcnt vmcnt(0) lgkmcnt(0)
    s_cbranch_scc1 back_16
    v_cmp_ne_u32 vcc, s100, v255
    s_cbranch_vccnz rl_63
    s_branch back_16
at_retry_17:
    s_mov_b32 s37, 0x100000
at_rl_64:
    s_sleep 2
    ds_read_b64 v[152:153], v5 offset:32776
    ds_read_b128 v[144:147], v5 offset:16384
    ds_read_b128 v[148:151], v5 offset:24576
    s_sub_u32 s37, s37, 1
    s_waitcnt lgkmcnt(0)
    s_cbranch_scc1 at_back_18
    v_cmp_ne_u32 vcc, 1, v153
    s_cbranch_vccnz at_rl_64
    s_branch at_back_18
mt_retry_19:
    s_mov_b32 s37, 0x100000
mt_rl_65:
    s_sleep 2
    v_xor_b32 v253, 4096, v4
    ds_read_b32 v253, v253 offset:32780
    s_sub_u32 s37, s37, 1
    s_waitcnt lgkmcnt(0)
    s_cbranch_scc1 mt_back_20
    v_cmp_gt_u32 vcc, 1, v253
    s_cbranch_vccnz mt_rl_65
    s_branch mt_back_20
at_retry_21:
    s_mov_b32 s37, 0x100000
at_rl_66:
    s_sleep 2
    ds_read_b64 v[152:153], v0 offset:32768
    ds_read_b128 v[144:147], v0 offset:0
    ds_read_b128 v[148:151], v0 offset:8192
    s_sub_u32 s37, s37, 1
    s_waitcnt lgkmcnt(0)
    s_cbranch_scc1 at_back_22
    v_cmp_ne_u32 vcc, 2, v153
    s_cbranch_vccnz at_rl_66
    s_branch at_back_22
mt_retry_23:
    s_mov_b32 s37, 0x100000
mt_rl_67:
    s_sleep 2
    v_xor_b32 v253, 4096, v5
    ds_read_b32 v253, v253 offset:32772
    s_sub_u32 s37, s37, 1
    s_waitcnt lgkmcnt(0)
    s_cbranch_scc1 mt_back_24
    v_cmp_gt_u32 vcc, 2, v253
    s_cbranch_vccnz mt_rl_67
    s_branch mt_back_24
at_retry_25:
    s_mov_b32 s37, 0x100000
at_rl_68:
    s_sleep 2
    ds_read_b64 v[152:153], v0 offset:32776
    ds_read_b128 v[144:147], v0 offset:16384
    ds_read_b128 v[148:151], v0 offset:24576
    s_sub_u32 s37, s37, 1
    s_waitcnt lgkmcnt(0)
    s_cbranch_scc1 at_back_26
    v_cmp_ne_u32 vcc, 2, v153
    s_cbranch_vccnz at_rl_68
    s_branch at_back_26
mt_retry_27:
    s_mov_b32 s37, 0x100000
mt_rl_69:
    s_sleep 2
    v_xor_b32 v253, 4096, v5
    ds_read_b32 v253, v253 offset:32780
    s_sub_u32 s37, s37, 1
    s_waitcnt lgkmcnt(0)
    s_cbranch_scc1 mt_back_28
    v_cmp_gt_u32 vcc, 2, v253
    s_cbranch_vccnz mt_rl_69
    s_branch mt_back_28
at_retry_29:
    s_mov_b32 s37, 0x100000
at_rl_70:
    s_sleep 2
    ds_read_b64 v[152:153], v7 offset:32768
    ds_read_b128 v[144:147], v7 offset:0
    ds_read_b128 v[148:151], v7 offset:8192
    s_sub_u32 s37, s37, 1
    s_waitcnt lgkmcnt(0)
    s_cbranch_scc1 at_back_30
    v_cmp_ne_u32 vcc, 3, v153
    s_cbranch_vccnz at_rl_70
    s_branch at_back_30
mt_retry_31:
    s_mov_b32 s37, 0x100000
mt_rl_71:
    s_sleep 2
    v_xor_b32 v253, 4096, v0
    ds_read_b32 v253, v253 offset:32772
    s_sub_u32 s37, s37, 1
    s_waitcnt lgkmcnt(0)
    s_cbranch_scc1 mt_back_32
    v_cmp_gt_u32 vcc, 3, v253
    s_cbranch_vccnz mt_rl_71
    s_branch mt_back_32
at_retry_33:
    s_mov_b32 s37, 0x100000
at_rl_72:
    s_sleep 2
    ds_read_b64 v[152:153], v7 offset:32776
    ds_read_b128 v[144:147], v7 offset:16384
    ds_read_b128 v[148:151], v7 offset:24576
    s_sub_u32 s37, s37, 1
    s_waitcnt lgkmcnt(0)
    s_cbranch_scc1 at_back_34
    v_cmp_ne_u32 vcc, 3, v153
    s_cbranch_vccnz at_rl_72
    s_branch at_back_34
mt_retry_35:
    s_mov_b32 s37, 0x100000
mt_rl_73:
    s_sleep 2
    v_xor_b32 v253, 4096, v0
    ds_read_b32 v253, v253 offset:32780
    s_sub_u32 s37, s37, 1
    s_waitcnt lgkmcnt(0)
    s_cbranch_scc1 mt_back_36
    v_cmp_gt_u32 vcc, 3, v253
    s_cbranch_vccnz mt_rl_73
    s_branch mt_back_36
at_retry_37:
    s_mov_b32 s37, 0x100000
at_rl_74:
    s_sleep 2
    ds_read_b64 v[112:113], v7 offset:32768
    ds_read_b128 v[104:107], v7 offset:0
    ds_read_b128 v[108:111], v7 offset:8192
    s_sub_u32 s37, s37, 1
    s_waitcnt lgkmcnt(0)
    s_cbranch_scc1 at_back_38
    v_cmp_ne_u32 vcc, 4, v113
    s_cbranch_vccnz at_rl_74
    s_branch at_back_38
at_fb_40:
    s_add_u32 s8, s33, 2097152
    s_mov_b32 s77, 64
    v_mov_b32 v204, 0xff800000
at_fb1_75:
    buffer_load_dwordx4 v[200:203], v2, s[24:27], s8 offen sc1
    s_waitcnt vmcnt(0)
    v_mfma_f32_32x32x16_bf16 v[104:119], v[200:203], v[164:167], 0
    s_nop 7
    s_nop 3
    v_max3_f32 v204, v104, v105, v204
    v_max3_f32 v204, v106, v107, v204
    v_max3_f32 v204, v108, v109, v204
    v_max3_f32 v204, v110, v111, v204
    v_max3_f32 v204, v112, v113, v204
    v_max3_f32 v204, v114, v115, v204
    v_max3_f32 v204, v116, v117, v204
    v_max3_f32 v204, v118, v119, v204
    s_add_u32 s8, s8, 1024
    s_sub_u32 s77, s77, 1
    s_cmp_lg_u32 s77, 0
    s_cbranch_scc1 at_fb1_75
    v_mov_b32 v205, v204
    s_nop 1
    v_permlane32_swap_b32 v204, v205
    s_nop 1
    v_max_f32 v204, v204, v205
    v_sub_f32 v120, 0, v204
    v_sub_f32 v121, 0, v204
    v_sub_f32 v122, 0, v204
    v_sub_f32 v123, 0, v204
    v_sub_f32 v124, 0, v204
    v_sub_f32 v125, 0, v204
    v_sub_f32 v126, 0, v204
    v_sub_f32 v127, 0, v204
    v_sub_f32 v128, 0, v204
    v_sub_f32 v129, 0, v204
    v_sub_f32 v130, 0, v204
    v_sub_f32 v131, 0, v204
    v_sub_f32 v132, 0, v204
    v_sub_f32 v133, 0, v204
    v_sub_f32 v134, 0, v204
    v_sub_f32 v135, 0, v204
    v_mov_b32 v144, 0
    v_mov_b32 v145, 0
    v_mov_b32 v146, 0
    v_mov_b32 v147, 0
    v_mov_b32 v148, 0
    v_mov_b32 v149, 0
    v_mov_b32 v150, 0
    v_mov_b32 v151, 0
    v_mov_b32 v152, 0
    v_mov_b32 v153, 0
    v_mov_b32 v154, 0
    v_mov_b32 v155, 0
    v_mov_b32 v156, 0
    v_mov_b32 v157, 0
    v_mov_b32 v158, 0
    v_mov_b32 v159, 0
    s_add_u32 s8, s33, 2097152
    s_add_u32 s9, s33, 4194304
    s_mov_b32 s77, 64
at_fb2_76:
    buffer_load_dwordx4 v[200:203], v2, s[24:27], s8 offen sc1
    s_mov_b32 exec_lo, 0xffff
    s_mov_b32 exec_hi, 0xffff
    buffer_load_dwordx4 v[40:43], v3, s[24:27], s9 offen sc1
    buffer_load_dwordx4 v[44:47], v3, s[24:27], s9 offen offset:512 sc1
    s_mov_b64 exec, -1
    s_waitcnt vmcnt(0)
    v_mfma_f32_32x32x16_bf16 v[104:119], v[200:203], v[164:167], v[120:135]
    s_nop 7
    s_nop 3
    v_exp_f32 v104, v104
    v_exp_f32 v105, v105
    v_exp_f32 v106, v106
    v_exp_f32 v107, v107
    v_exp_f32 v108, v108
    v_exp_f32 v109, v109
    v_exp_f32 v110, v110
    v_exp_f32 v111, v111
    v_exp_f32 v112, v112
    v_exp_f32 v113, v113
    v_exp_f32 v114, v114
    v_exp_f32 v115, v115
    v_exp_f32 v116, v116
    v_exp_f32 v117, v117
    v_exp_f32 v118, v118
    v_exp_f32 v119, v119
    s_nop 0
    v_cvt_pk_bf16_f32 v136, v104, v105
    v_cvt_pk_bf16_f32 v137, v106, v107
    v_cvt_pk_bf16_f32 v138, v108, v109
    v_cvt_pk_bf16_f32 v139, v110, v111
    v_cvt_pk_bf16_f32 v140, v112, v113
    v_cvt_pk_bf16_f32 v141, v114, v115
    v_cvt_pk_bf16_f32 v142, v116, v117
    v_cvt_pk_bf16_f32 v143, v118, v119
    s_nop 1
    v_mfma_f32_32x32x16_bf16 v[144:159], v[40:43], v[136:139], v[144:159]
    v_mfma_f32_32x32x16_bf16 v[144:159], v[44:47], v[140:143], v[144:159]
    s_nop 7
    s_nop 7
    s_add_u32 s8, s8, 1024
    s_add_u32 s9, s9, 1024
    s_sub_u32 s77, s77, 1
    s_cmp_lg_u32 s77, 0
    s_cbranch_scc1 at_fb2_76
    s_branch at_fin_39
p4_again_56:
    s_mov_b32 s37, 131072
p4_rl_77:
    s_sleep 2
    s_bitcmp0_b32 s36, 0
    s_cbranch_scc1 p4_r1_78
    s_add_u32 s59, s2, 1
    s_and_b32 s59, s59, 7
    s_lshl_b32 s59, s59, 12
    s_add_u32 s59, s59, s56
    buffer_load_dwordx4 v[8:11], v2, s[24:27], s59 offen sc1
p4_r1_78:
    s_bitcmp0_b32 s36, 1
    s_cbranch_scc1 p4_r1_79
    s_add_u32 s59, s2, 2
    s_and_b32 s59, s59, 7
    s_lshl_b32 s59, s59, 12
    s_add_u32 s59, s59, s56
    buffer_load_dwordx4 v[12:15], v2, s[24:27], s59 offen sc1
p4_r1_79:
    s_bitcmp0_b32 s36, 2
    s_cbranch_scc1 p4_r1_80
    s_add_u32 s59, s2, 3
    s_and_b32 s59, s59, 7
    s_lshl_b32 s59, s59, 12
    s_add_u32 s59, s59, s56
    buffer_load_dwordx4 v[16:19], v2, s[24:27], s59 offen sc1
p4_r1_80:
    s_bitcmp0_b32 s36, 3
    s_cbranch_scc1 p4_r1_81
    s_add_u32 s59, s2, 4
    s_and_b32 s59, s59, 7
    s_lshl_b32 s59, s59, 12
    s_add_u32 s59, s59, s56
    buffer_load_dwordx4 v[20:23], v2, s[24:27], s59 offen sc1
p4_r1_81:
    s_bitcmp0_b32 s36, 4
    s_cbranch_scc1 p4_r1_82
    s_add_u32 s59, s2, 5
    s_and_b32 s59, s59, 7
    s_lshl_b32 s59, s59, 12
    s_add_u32 s59, s59, s56
    buffer_load_dwordx4 v[24:27], v2, s[24:27], s59 offen sc1
p4_r1_82:
    s_bitcmp0_b32 s36, 5
    s_cbranch_scc1 p4_r1_83
    s_add_u32 s59, s2, 6
    s_and_b32 s59, s59, 7
    s_lshl_b32 s59, s59, 12
    s_add_u32 s59, s59, s56
    buffer_load_dwordx4 v[28:31], v2, s[24:27], s59 offen sc1
p4_r1_83:
    s_bitcmp0_b32 s36, 6
    s_cbranch_scc1 p4_r1_84
    s_add_u32 s59, s2, 7
    s_and_b32 s59, s59, 7
    s_lshl_b32 s59, s59, 12
    s_add_u32 s59, s59, s56
    buffer_load_dwordx4 v[32:35], v2, s[24:27], s59 offen sc1
p4_r1_84:
    s_bitcmp0_b32 s36, 7
    s_cbranch_scc1 p4_r1_85
    s_add_u32 s59, s2, 8
    s_and_b32 s59, s59, 7
    s_lshl_b32 s59, s59, 12
    s_add_u32 s59, s59, s56
    buffer_load_dwordx4 v[36:39], v2, s[24:27], s59 offen sc1
p4_r1_85:
    s_waitcnt vmcnt(0)
    s_bitcmp0_b32 s36, 0
    s_cbranch_scc1 p4_r2_86
    v_max3_u32 v112, v8, v9, v10
    v_max_u32 v112, v11, v112
    v_cmp_eq_u32 vcc, -1, v112
    s_cbranch_vccnz p4_r2_86
    s_bitset0_b32 s36, 0
    v_mfma_f32_32x32x16_bf16 v[168:183], v[40:43], v[8:11], v[168:183]
    v_mfma_f32_32x32x16_bf16 v[184:199], v[44:47], v[8:11], v[184:199]
p4_r2_86:
    s_bitcmp0_b32 s36, 1
    s_cbranch_scc1 p4_r2_87
    v_max3_u32 v112, v12, v13, v14
    v_max_u32 v112, v15, v112
    v_cmp_eq_u32 vcc, -1, v112
    s_cbranch_vccnz p4_r2_87
    s_bitset0_b32 s36, 1
    v_mfma_f32_32x32x16_bf16 v[168:183], v[48:51], v[12:15], v[168:183]
    v_mfma_f32_32x32x16_bf16 v[184:199], v[52:55], v[12:15], v[184:199]
p4_r2_87:
    s_bitcmp0_b32 s36, 2
    s_cbranch_scc1 p4_r2_88
    v_max3_u32 v112, v16, v17, v18
    v_max_u32 v112, v19, v112
    v_cmp_eq_u32 vcc, -1, v112
    s_cbranch_vccnz p4_r2_88
    s_bitset0_b32 s36, 2
    v_mfma_f32_32x32x16_bf16 v[168:183], v[56:59], v[16:19], v[168:183]
    v_mfma_f32_32x32x16_bf16 v[184:199], v[60:63], v[16:19], v[184:199]
p4_r2_88:
    s_bitcmp0_b32 s36, 3
    s_cbranch_scc1 p4_r2_89
    v_max3_u32 v112, v20, v21, v22
    v_max_u32 v112, v23, v112
    v_cmp_eq_u32 vcc, -1, v112
    s_cbranch_vccnz p4_r2_89
    s_bitset0_b32 s36, 3
    v_mfma_f32_32x32x16_bf16 v[168:183], v[64:67], v[20:23], v[168:183]
    v_mfma_f32_32x32x16_bf16 v[184:199], v[68:71], v[20:23], v[184:199]
p4_r2_89:
    s_bitcmp0_b32 s36, 4
    s_cbranch_scc1 p4_r2_90
    v_max3_u32 v112, v24, v25, v26
    v_max_u32 v112, v27, v112
    v_cmp_eq_u32 vcc, -1, v112
    s_cbranch_vccnz p4_r2_90
    s_bitset0_b32 s36, 4
    v_mfma_f32_32x32x16_bf16 v[168:183], v[72:75], v[24:27], v[168:183]
    v_mfma_f32_32x32x16_bf16 v[184:199], v[76:79], v[24:27], v[184:199]
p4_r2_90:
    s_bitcmp0_b32 s36, 5
    s_cbranch_scc1 p4_r2_91
    v_max3_u32 v112, v28, v29, v30
    v_max_u32 v112, v31, v112
    v_cmp_eq_u32 vcc, -1, v112
    s_cbranch_vccnz p4_r2_91
    s_bitset0_b32 s36, 5
    v_mfma_f32_32x32x16_bf16 v[168:183], v[80:83], v[28:31], v[168:183]
    v_mfma_f32_32x32x16_bf16 v[184:199], v[84:87], v[28:31], v[184:199]
p4_r2_91:
    s_bitcmp0_b32 s36, 6
    s_cbranch_scc1 p4_r2_92
    v_max3_u32 v112, v32, v33, v34
    v_max_u32 v112, v35, v112
    v_cmp_eq_u32 vcc, -1, v112
    s_cbranch_vccnz p4_r2_92
    s_bitset0_b32 s36, 6
    v_mfma_f32_32x32x16_bf16 v[168:183], v[88:91], v[32:35], v[168:183]
    v_mfma_f32_32x32x16_bf16 v[184:199], v[92:95], v[32:35], v[184:199]
p4_r2_92:
    s_bitcmp0_b32 s36, 7
    s_cbranch_scc1 p4_r2_93
    v_max3_u32 v112, v36, v37, v38
    v_max_u32 v112, v39, v112
    v_cmp_eq_u32 vcc, -1, v112
    s_cbranch_vccnz p4_r2_93
    s_bitset0_b32 s36, 7
    v_mfma_f32_32x32x16_bf16 v[168:183], v[96:99], v[36:39], v[168:183]
    v_mfma_f32_32x32x16_bf16 v[184:199], v[100:103], v[36:39], v[184:199]
p4_r2_93:
    s_cmp_eq_u32 s36, 0
    s_cbranch_scc1 p4_done_57
    s_sub_u32 s37, s37, 1
    s_cbranch_scc0 p4_rl_77
    s_branch p4_done_57
cpf_end:
    s_endpgm
.section .rodata,"a"
.p2align 6
.amdhsa_kernel gated_mix__mha_block__geglu_ffn__prompt_kernel
.amdhsa_next_free_vgpr 256
.amdhsa_next_free_sgpr 102
.amdhsa_accum_offset 256
.amdhsa_group_segment_fixed_size 0
.amdhsa_kernarg_size 88
.amdhsa_user_sgpr_count 2
.amdhsa_user_sgpr_kernarg_segment_ptr 1
.amdhsa_system_sgpr_workgroup_id_x 1
.end_amdhsa_kernel
```
